```python
import torch

def _softmax(x, axis=-1):
    return torch.softmax(x, dim=axis)
def _gelu(x):
    return torch.nn.functional.gelu(x, approximate="tanh")
def _silu(x):
    return torch.nn.functional.silu(x)
def _sigmoid(x):
    return torch.sigmoid(x)
def _layernorm(x, axis=-1, eps=1e-5):
    m = x.mean(dim=axis, keepdim=True)
    v = x.var(dim=axis, keepdim=True, unbiased=False)
    return (x - m) / torch.sqrt(v + eps)
def _scatter_add(tgt, idx, src, axis=0):
    return tgt.clone().index_add_(axis, idx, src)
def _segment_sum(src, seg, n):
    out = torch.zeros((n,) + src.shape[1:], dtype=src.dtype)
    return out.index_add_(0, seg, src)
def _pad(x, pw):
    flat = tuple(v for pair in reversed(pw) for v in pair)
    return torch.nn.functional.pad(x, flat)

kernel_name = 'recurrent_scan__spectral_fnet__moe_arch_mod__prompt'

def setup_inputs():

    _w = (lambda a: (lambda t: t.to(torch.bfloat16) if t.is_floating_point() else t)(torch.as_tensor(a)))
    def _A_setup():
        B, S, D = 1, 2048, 640
        ns = torch.arange(S)[:, None] * torch.arange(S)[None, :]
        nd = torch.arange(D)[:, None] * torch.arange(D)[None, :]
        Ws_re = torch.cos(-2.0 * torch.pi * ns / S).to(float)
        Ws_im = torch.sin(-2.0 * torch.pi * ns / S).to(float)
        Wd_re = torch.cos(-2.0 * torch.pi * nd / D).to(float)
        Wd_im = torch.sin(-2.0 * torch.pi * nd / D).to(float)
        return {
            "x": _w((lambda *s: torch.randn(*s, dtype=torch.bfloat16) * 0.1)(B, S, D)),
            "dft_seq_re": _w(Ws_re),
            "dft_seq_im": _w(Ws_im),
            "dft_hid_re": _w(Wd_re),
            "dft_hid_im": _w(Wd_im),
        }
    _A_in = _A_setup()

    def _B_setup():
        B, S, D, F, C = 1, 2048, 640, 1728, 2
        return {
            "x": _w((lambda *s: torch.randn(*s, dtype=torch.bfloat16) * 0.1)(B, S, D)),
            "w_r": _w((lambda *s: torch.randn(*s, dtype=torch.bfloat16) * 0.1)(D)),
            "w_gate": _w((lambda *s: torch.randn(*s, dtype=torch.bfloat16) * 0.1)(D, F)),
            "w_up": _w((lambda *s: torch.randn(*s, dtype=torch.bfloat16) * 0.1)(D, F)),
            "w_down": _w((lambda *s: torch.randn(*s, dtype=torch.bfloat16) * 0.1)(F, D)),
        }
    _B_in = _B_setup()

    return {
        "A_x": _A_in["x"],
        "A_dft_seq_re": _A_in["dft_seq_re"],
        "A_dft_seq_im": _A_in["dft_seq_im"],
        "A_dft_hid_re": _A_in["dft_hid_re"],
        "A_dft_hid_im": _A_in["dft_hid_im"],
        "B_x": _B_in["x"],
        "B_w_r": _B_in["w_r"],
        "B_w_gate": _B_in["w_gate"],
        "B_w_up": _B_in["w_up"],
        "B_w_down": _B_in["w_down"],
    }

def reference(A_x, A_dft_seq_re, A_dft_seq_im, A_dft_hid_re, A_dft_hid_im, B_x, B_w_r, B_w_gate, B_w_up, B_w_down):
    def _A_ref(x, dft_seq_re, dft_seq_im, dft_hid_re, dft_hid_im):
        a = torch.einsum("bsd,ed->bse", x, dft_hid_re)
        b = torch.einsum("bsd,ed->bse", x, dft_hid_im)
        y = torch.einsum("ts,bse->bte", dft_seq_re, a) - torch.einsum("ts,bse->bte", dft_seq_im, b)
        return y

    def _B_ref(x, w_r, w_gate, w_up, w_down):
        B, S, D = x.shape
        C = 2
        r = x @ w_r
        idx = torch.argsort(-r, axis=-1)[:, :C]
        idx_e = (lambda x, n, axis: torch.repeat_interleave(x, n, dim=axis))(idx.reshape(B, C, 1), D, axis=2)
        x_sel = (lambda x, i, axis: torch.take_along_dim(x, i, dim=axis))(x, idx_e, axis=1)
        g = _silu(x_sel @ w_gate)
        u = x_sel @ w_up
        y = (g * u) @ w_down
        r_sel = _sigmoid((lambda x, i, axis: torch.take_along_dim(x, i, dim=axis))(r, idx, axis=1))
        y = y * r_sel.reshape(B, C, 1)
        b_off = (torch.arange(B) * S).reshape(B, 1)
        flat_idx = (idx + b_off).reshape(B * C)
        zero = (x * 0.0).reshape(B * S, D)
        upd = _scatter_add(zero, flat_idx, y.reshape(B * C, D), axis=0)
        return x + upd.reshape(B, S, D)

    x = A_x
    xn = _layernorm(x, axis=-1)
    s = _A_ref(xn, A_dft_seq_re, A_dft_seq_im, A_dft_hid_re, A_dft_hid_im)
    g = _silu(_B_ref(xn, B_w_r, B_w_gate, B_w_up, B_w_down))
    return x + s * g
```

```asm
; @launch grid=(256,1,1) block=(640,1,1) lds=96816
.amdgcn_target "amdgcn-amd-amdhsa--gfx950"
.text
.globl recurrent_scan__spectral_fnet__moe_arch_mod__prompt_kernel
.p2align 8
.type recurrent_scan__spectral_fnet__moe_arch_mod__prompt_kernel,@function
recurrent_scan__spectral_fnet__moe_arch_mod__prompt_kernel:
    s_getpc_b64 s[6:7]
    s_cmp_ge_u32 s2, 256
    s_cbranch_scc1 k_end
    v_lshlrev_b32 v3, 7, v0
    v_subrev_u32 v3, 65536, v3
    v_cmp_gt_u32 vcc, k_last-recurrent_scan__spectral_fnet__moe_arch_mod__prompt_kernel-4, v3
    s_and_saveexec_b64 s[20:21], vcc
    s_cbranch_execz k_ncp
    global_load_dword v165, v3, s[6:7]
k_ncp:
    s_mov_b64 exec, -1
    s_load_dwordx2 s[4:5], s[0:1], 0
    s_load_dwordx4 s[16:19], s[0:1], 88
    s_load_dwordx8 s[8:15], s[0:1], 48
    s_load_dwordx2 s[20:21], s[0:1], 80
    v_lshrrev_b32 v3, 6, v0
    v_and_b32 v0, 63, v0
    v_readfirstlane_b32 s42, v3
    v_and_b32 v1, 31, v0
    v_lshrrev_b32 v2, 5, v0
    s_mov_b32 s45, 0xffff0000
    s_mov_b32 s26, 0x00280000
    s_mov_b32 s27, 0x00020000
    s_mov_b32 s30, 0x001c3000
    s_mov_b32 s31, 0x00020000
    s_mov_b32 s35, 0x00020000
    s_mov_b32 s39, 0x00020000
    s_sub_u32 s43, s2, 129
    s_cmp_lt_u32 s43, 54
    s_cbranch_scc1 k_ffn
    s_cmp_ge_u32 s2, 129
    s_cbranch_scc1 k_other
    s_mov_b32 s66, s2
    v_lshlrev_b32 v14, 4, v0
    s_setprio 3
    v_lshlrev_b32 v6, 3, v0
    v_lshlrev_b32 v7, 2, v0
    s_cmp_ge_u32 s42, 8
    s_cbranch_scc1 k_helper
    s_lshl_b32 s43, s42, 8
    s_add_u32 s43, s43, s2
    s_sub_u32 s44, 2048, s43
    s_and_b32 s44, s44, 2047
    s_mul_i32 s48, s43, 1280
    s_mul_i32 s49, s44, 1280
    v_sub_u32 v8, 1264, v14
    v_sub_u32 v9, 252, v7
    s_movk_i32 s34, 1280
    s_mov_b32 s47, 0x3f803f80
    s_cmp_lg_u32 s42, 0
    s_waitcnt lgkmcnt(0)
    s_mov_b64 s[24:25], s[4:5]
    s_mov_b64 s[28:29], s[18:19]
    s_cbranch_scc1 k_now
    s_mov_b64 s[32:33], s[8:9]
    buffer_load_dwordx4 v[40:43], v14, s[32:35], 0 offen
    buffer_load_dword v44, v7, s[32:35], 0 offen offset:1024
k_now:
    buffer_load_dwordx4 v[20:23], v8, s[24:27], s48 offen
    buffer_load_dword v33, v9, s[24:27], s48 offen
    buffer_load_dwordx4 v[16:19], v14, s[24:27], s49 offen
    buffer_load_dword v32, v7, s[24:27], s49 offen offset:1024
    s_cmp_ge_u32 s42, 5
    s_cselect_b32 s43, 1, 0
    v_lshrrev_b32 v3, s43, v1
    v_and_b32 v4, s43, v1
    s_cselect_b32 s43, 40, 16
    s_mov_b32 s65, 0xbacccccd
    s_cselect_b32 s65, 0xbd4ccccd, s65
    v_cvt_f32_u32 v60, v3
    v_cvt_f32_u32 v62, v4
    s_lshl_b32 s44, s42, 3
    s_sub_u32 s44, s44, s43
    s_lshl_b32 s43, s42, 2
    s_cmp_lt_u32 s42, 2
    s_cselect_b32 s43, s43, s44
    s_cselect_b32 s44, 3, 2
    s_cselect_b32 s65, 0xbd000000, s65
    v_lshlrev_b32 v3, s44, v2
    v_add_u32 v3, s43, v3
    v_cvt_f32_u32 v61, v3
    v_mul_f32 v60, s65, v60
    v_mul_f32 v62, 0x3e800000, v62
    v_fma_f32 v61, v61, v60, v62
    v_cos_f32 v64, v61
    v_sin_f32 v68, v61
    v_add_f32 v61, v61, v60
    v_cos_f32 v65, v61
    v_sin_f32 v69, v61
    v_add_f32 v61, v61, v60
    v_cos_f32 v66, v61
    v_sin_f32 v70, v61
    v_add_f32 v61, v61, v60
    v_cos_f32 v67, v61
    v_sin_f32 v71, v61
    s_cbranch_scc1 k_cwB
    s_lshl_b32 s43, s42, 10
    v_add_u32 v3, s43, v14
    v_cvt_pk_f16_f32 v72, v64, v68
    v_cvt_pk_f16_f32 v73, v65, v69
    v_cvt_pk_f16_f32 v74, v66, v70
    v_cvt_pk_f16_f32 v75, v67, v71
    s_cmp_eq_u32 s42, 7
    s_cselect_b32 s43, 32, 64
    v_cmp_gt_u32 vcc, s43, v0
    s_nop 1
    v_cndmask_b32 v72, 0, v72, vcc
    v_cndmask_b32 v73, 0, v73, vcc
    v_cndmask_b32 v74, 0, v74, vcc
    v_cndmask_b32 v75, 0, v75, vcc
    ds_write_b128 v3, v[72:75] offset:27648
    s_branch k_bar0
k_cwB:
    v_and_b32 v4, 1, v1
    v_mul_u32_u24 v4, 0x8000, v4
    v_cvt_pk_f16_f32 v72, v64, v65
    v_cvt_pk_f16_f32 v73, v66, v67
    v_lshl_or_b32 v4, v4, 16, v4
    v_cvt_pk_f16_f32 v76, -v68, -v69
    v_cvt_pk_f16_f32 v77, -v70, -v71
    v_lshl_add_u32 v3, s42, 3, v14
    v_xor_b32 v74, v4, v72
    v_xor_b32 v75, v4, v73
    v_xor_b32 v78, v4, v76
    v_xor_b32 v79, v4, v77
    ds_write_b64 v3, v[72:73] offset:22528
    ds_write_b64 v3, v[74:75] offset:23552
    ds_write_b64 v3, v[76:77] offset:24576
    ds_write_b64 v3, v[78:79] offset:25600
k_bar0:
    s_cmp_lg_u32 s42, 0
    s_cbranch_scc1 k_bar0b
    s_waitcnt vmcnt(4)
    ds_write_b128 v14, v[40:43] offset:43696
    ds_write_b32 v7, v44 offset:44720
k_bar0b:
    s_and_b32 s67, s66, 15
    s_lshr_b32 s68, s66, 4
    s_and_b32 s52, s42, 3
    s_lshr_b32 s70, s42, 2
    s_lshl4_add_u32 s69, s52, s67
    s_sub_u32 s43, 64, s69
    s_and_b32 s43, s43, 63
    s_cselect_b32 s53, 32, 33
    s_lshl_b32 s44, s68, 6
    s_sub_u32 s61, 1216, s44
    s_cmp_eq_u32 s70, 0
    s_cselect_b32 s69, s69, s43
    s_cselect_b32 s44, s44, s61
    s_cselect_b32 s53, 0, s53
    s_cselect_b32 s54, 0, -1
    s_mul_i32 s43, s69, 1280
    s_add_u32 s60, s43, s44
    s_add_u32 s61, s60, 1310720
    v_lshl_add_u32 v3, v1, 6, s69
    v_sub_u32 v4, 2048, v3
    v_and_b32 v5, 255, v3
    v_cmp_lt_u32 vcc, 128, v5
    s_nop 1
    v_cndmask_b32 v4, v3, v4, vcc
    v_cndmask_b32 v164, 0, 8, vcc
    v_and_b32 v5, 255, v4
    v_lshrrev_b32 v4, 8, v4
    v_mul_u32_u24 v5, 128, v5
    v_add_u32 v164, v5, v164
    v_lshl_add_u32 v164, v4, 4, v164
    s_mov_b32 s55, 0x00001000
    v_mov_b32 v80, 0
    v_mov_b32 v81, 0
    v_mov_b32 v82, 0
    v_mov_b32 v83, 0
    v_mov_b32 v84, 0
    v_mov_b32 v85, 0
    s_lshl_b32 s43, s42, 4
    s_add_u32 s43, s43, 43008
    v_lshl_add_u32 v10, v2, 3, s43
    s_mul_i32 s49, s42, 1280
    v_add_u32 v12, s49, v14
    v_add_u32 v13, s49, v7
    s_lshr_b32 s43, s42, 2
    s_mul_i32 s43, s43, 6144
    s_and_b32 s44, s42, 3
    s_lshl2_add_u32 s65, s44, s43
    s_waitcnt lgkmcnt(0)
    s_barrier
    ds_read_b128 v[24:27], v8 offset:43696
    ds_read_b32 v34, v9 offset:43696
    ds_read_b128 v[28:31], v14 offset:43696
    ds_read_b32 v35, v7 offset:44720
    ds_read_b32 v11, v14 offset:44976
    ds_read_b128 v[152:155], v14 offset:37888
    ds_read_b128 v[92:95], v14 offset:22528
    ds_read_b128 v[96:99], v14 offset:23552
    ds_read_b128 v[100:103], v14 offset:24576
    ds_read_b128 v[104:107], v14 offset:25600
    s_waitcnt vmcnt(2)
    v_dot2c_f32_bf16 v80, s47, v20
    v_dot2c_f32_bf16 v81, v20, v20
    v_dot2c_f32_bf16 v80, s47, v21
    v_dot2c_f32_bf16 v81, v21, v21
    v_dot2c_f32_bf16 v80, s47, v22
    v_dot2c_f32_bf16 v81, v22, v22
    v_dot2c_f32_bf16 v80, s47, v23
    v_dot2c_f32_bf16 v81, v23, v23
    v_dot2c_f32_bf16 v80, s47, v33
    v_dot2c_f32_bf16 v81, v33, v33
    s_waitcnt vmcnt(0)
    v_dot2c_f32_bf16 v83, s47, v16
    v_dot2c_f32_bf16 v84, v16, v16
    v_dot2c_f32_bf16 v83, s47, v17
    v_dot2c_f32_bf16 v84, v17, v17
    v_dot2c_f32_bf16 v83, s47, v18
    v_dot2c_f32_bf16 v84, v18, v18
    v_dot2c_f32_bf16 v83, s47, v19
    v_dot2c_f32_bf16 v84, v19, v19
    v_dot2c_f32_bf16 v83, s47, v32
    v_dot2c_f32_bf16 v84, v32, v32
    s_waitcnt lgkmcnt(5)
    v_dot2c_f32_bf16 v82, v20, v24
    v_dot2c_f32_bf16 v85, v16, v28
    v_dot2c_f32_bf16 v82, v21, v25
    v_dot2c_f32_bf16 v85, v17, v29
    v_dot2c_f32_bf16 v82, v22, v26
    v_dot2c_f32_bf16 v85, v18, v30
    v_dot2c_f32_bf16 v82, v23, v27
    v_dot2c_f32_bf16 v85, v19, v31
    v_dot2c_f32_bf16 v82, v33, v34
    v_dot2c_f32_bf16 v85, v32, v35
    v_permlane32_swap_b32 v80, v83
    v_permlane32_swap_b32 v81, v84
    v_add_f32 v80, v80, v83
    v_add_f32 v81, v81, v84
    v_permlane32_swap_b32 v82, v85
    v_add_f32 v82, v82, v85
    v_add_f32_dpp v80, v80, v80 quad_perm:[1,0,3,2] row_mask:0xf bank_mask:0xf
    v_add_f32_dpp v81, v81, v81 quad_perm:[1,0,3,2] row_mask:0xf bank_mask:0xf
    v_add_f32_dpp v82, v82, v82 quad_perm:[1,0,3,2] row_mask:0xf bank_mask:0xf
    v_add_f32_dpp v80, v80, v80 quad_perm:[2,3,0,1] row_mask:0xf bank_mask:0xf
    v_add_f32_dpp v81, v81, v81 quad_perm:[2,3,0,1] row_mask:0xf bank_mask:0xf
    v_add_f32_dpp v82, v82, v82 quad_perm:[2,3,0,1] row_mask:0xf bank_mask:0xf
    v_add_f32_dpp v80, v80, v80 row_half_mirror row_mask:0xf bank_mask:0xf
    v_add_f32_dpp v81, v81, v81 row_half_mirror row_mask:0xf bank_mask:0xf
    v_add_f32_dpp v82, v82, v82 row_half_mirror row_mask:0xf bank_mask:0xf
    v_add_f32_dpp v80, v80, v80 row_mirror row_mask:0xf bank_mask:0xf
    v_add_f32_dpp v81, v81, v81 row_mirror row_mask:0xf bank_mask:0xf
    v_add_f32_dpp v82, v82, v82 row_mirror row_mask:0xf bank_mask:0xf
    v_add_f32_dpp v80, v80, v80 row_bcast:15 row_mask:0xa bank_mask:0xf
    v_add_f32_dpp v81, v81, v81 row_bcast:15 row_mask:0xa bank_mask:0xf
    v_add_f32_dpp v82, v82, v82 row_bcast:15 row_mask:0xa bank_mask:0xf
    v_mul_f32 v60, 0x3acccccd, v80
    v_mul_f32 v62, 0x3acccccd, v81
    v_fma_f32 v62, -v60, v60, v62
    v_cvt_pk_bf16_f32 v61, v60, v60
    v_max_f32 v62, 0, v62
    v_cvt_pk_bf16_f32 v62, v62, v62
    v_and_b32 v62, s45, v62
    v_add_f32 v62, 0x3727c5ac, v62
    v_cvt_pk_bf16_f32 v62, v62, v62
    v_and_b32 v62, s45, v62
    v_sqrt_f32 v62, v62
    v_and_b32 v61, s45, v61
    v_cvt_pk_bf16_f32 v89, v62, v62
    v_bfi_b32 v83, s45, v61, v89
    s_mov_b32 exec_lo, 0x80000000
    s_mov_b32 exec_hi, 0x80000000
    ds_write_b64 v10, v[82:83]
    s_mov_b64 exec, -1
    s_setprio 2
    v_and_b32 v62, s45, v89
    v_rcp_f32 v63, v62
    ds_read_b128 v[120:123], v14 offset:29696
    ds_read_b128 v[124:127], v14 offset:30720
    ds_read_b128 v[128:131], v14 offset:31744
    v_mul_f32 v88, -v61, v63
    v_cvt_f32_bf16_dpp v50, v33 wave_ror:1 row_mask:0xf bank_mask:0xf
    v_cvt_f32_bf16_dpp v58, v20 wave_ror:1 row_mask:0xf bank_mask:0xf
    v_add_f32_dpp v88, v88, v88 row_bcast:31 row_mask:0xc bank_mask:0xf
    v_readlane_b32 s40, v63, 31
    v_readlane_b32 s22, v63, 63
    v_readlane_b32 s43, v88, 63
    v_cvt_f32_bf16_dpp v50, v20 wave_shr:1 row_mask:0xf bank_mask:0xf
    v_cvt_f32_bf16_dpp v58, v33 wave_shr:1 row_mask:0xf bank_mask:0xf
    s_mov_b32 s41, s40
    s_mov_b32 s23, s22
    v_mov_b32 v90, s43
    v_mov_b32 v91, s43
    v_lshlrev_b32 v40, 16, v16
    v_and_b32 v41, s45, v16
    v_lshlrev_b32 v42, 16, v17
    v_and_b32 v43, s45, v17
    v_lshlrev_b32 v44, 16, v18
    v_and_b32 v45, s45, v18
    v_lshlrev_b32 v46, 16, v19
    v_and_b32 v47, s45, v19
    v_lshlrev_b32 v48, 16, v32
    v_and_b32 v49, s45, v32
    v_pk_fma_f32 v[40:41], v[40:41], s[22:23], v[90:91]
    v_pk_fma_f32 v[42:43], v[42:43], s[22:23], v[90:91]
    v_pk_fma_f32 v[44:45], v[44:45], s[22:23], v[90:91]
    v_pk_fma_f32 v[46:47], v[46:47], s[22:23], v[90:91]
    v_pk_fma_f32 v[48:49], v[48:49], s[22:23], v[90:91]
    v_and_b32 v57, s45, v20
    v_and_b32 v55, s45, v21
    v_lshlrev_b32 v56, 16, v21
    v_and_b32 v53, s45, v22
    v_lshlrev_b32 v54, 16, v22
    v_and_b32 v51, s45, v23
    v_lshlrev_b32 v52, 16, v23
    v_and_b32 v59, s45, v33
    v_pk_fma_f32 v[40:41], v[50:51], s[40:41], v[40:41]
    v_pk_fma_f32 v[42:43], v[52:53], s[40:41], v[42:43]
    v_pk_fma_f32 v[44:45], v[54:55], s[40:41], v[44:45]
    v_pk_fma_f32 v[46:47], v[56:57], s[40:41], v[46:47]
    v_pk_fma_f32 v[48:49], v[58:59], s[40:41], v[48:49]
    v_cvt_pk_f16_f32 v80, v40, v41
    v_cvt_pk_f16_f32 v81, v42, v43
    v_cvt_pk_f16_f32 v82, v44, v45
    v_cvt_pk_f16_f32 v83, v46, v47
    v_cvt_pk_f16_f32 v84, v48, v49
    s_waitcnt lgkmcnt(0)
    v_add_u32 v152, s49, v152
    ds_write_b128 v12, v[80:83]
    ds_write_b32 v13, v84 offset:1024
    ds_read_b64_tr_b16 v[16:17], v152 offset:0
    ds_read_b64_tr_b16 v[18:19], v152 offset:160
    ds_read_b64_tr_b16 v[20:21], v152 offset:640
    ds_read_b64_tr_b16 v[22:23], v152 offset:800
    ds_read_b128 v[132:135], v14 offset:32768
    ds_read_b128 v[136:139], v14 offset:33792
    ds_read_b128 v[140:143], v14 offset:34816
    ds_read_b128 v[144:147], v14 offset:35840
    ds_read_b128 v[148:151], v14 offset:36864
    buffer_load_dwordx4 v[156:159], v11, s[24:27], s60 offen
    buffer_load_dwordx4 v[160:163], v11, s[24:27], s61 offen
    v_add_u32 v153, s65, v153
    s_lshl_b32 s43, s42, 9
    v_add_u32 v154, s43, v154
    s_mul_i32 s48, s42, 16512
    s_lshl_b32 s44, s2, 7
    s_add_u32 s48, s48, s44
    s_add_u32 s48, s48, 0x00060000
    s_waitcnt lgkmcnt(7)
    v_mfma_f32_32x32x16_f16 v[60:75], v[16:19], v[92:95], 0
    v_mfma_f32_32x32x16_f16 v[76:91], v[16:19], v[100:103], 0
    s_waitcnt lgkmcnt(5)
    v_mfma_f32_32x32x16_f16 v[60:75], v[20:23], v[96:99], v[60:75]
    v_mfma_f32_32x32x16_f16 v[76:91], v[20:23], v[104:107], v[76:91]
    s_setprio 1
    s_waitcnt lgkmcnt(0)
    s_nop 9
    v_cvt_pk_f16_f32 v40, v60, v76
    v_cvt_pk_f16_f32 v41, v61, v77
    v_cvt_pk_f16_f32 v42, v62, v78
    v_cvt_pk_f16_f32 v43, v63, v79
    v_pk_mul_f16 v52, v40, v120 op_sel_hi:[1,0]
    v_pk_mul_f16 v53, v41, v121 op_sel_hi:[1,0]
    v_pk_mul_f16 v54, v42, v122 op_sel_hi:[1,0]
    v_pk_mul_f16 v55, v43, v123 op_sel_hi:[1,0]
    v_pk_fma_f16 v40, v40, v120, v52 op_sel:[1,1,0] op_sel_hi:[0,1,1] neg_hi:[1,0,0]
    v_pk_fma_f16 v41, v41, v121, v53 op_sel:[1,1,0] op_sel_hi:[0,1,1] neg_hi:[1,0,0]
    v_pk_fma_f16 v42, v42, v122, v54 op_sel:[1,1,0] op_sel_hi:[0,1,1] neg_hi:[1,0,0]
    v_pk_fma_f16 v43, v43, v123, v55 op_sel:[1,1,0] op_sel_hi:[0,1,1] neg_hi:[1,0,0]
    s_nop 1
    v_mfma_f32_32x32x16_f16 v[92:107], v[132:135], v[40:43], 0
    v_cvt_pk_f16_f32 v44, v64, v80
    v_cvt_pk_f16_f32 v45, v65, v81
    v_cvt_pk_f16_f32 v46, v66, v82
    v_cvt_pk_f16_f32 v47, v67, v83
    v_pk_mul_f16 v52, v44, v124 op_sel_hi:[1,0]
    v_pk_mul_f16 v53, v45, v125 op_sel_hi:[1,0]
    v_pk_mul_f16 v54, v46, v126 op_sel_hi:[1,0]
    v_pk_mul_f16 v55, v47, v127 op_sel_hi:[1,0]
    v_pk_fma_f16 v44, v44, v124, v52 op_sel:[1,1,0] op_sel_hi:[0,1,1] neg_hi:[1,0,0]
    v_pk_fma_f16 v45, v45, v125, v53 op_sel:[1,1,0] op_sel_hi:[0,1,1] neg_hi:[1,0,0]
    v_pk_fma_f16 v46, v46, v126, v54 op_sel:[1,1,0] op_sel_hi:[0,1,1] neg_hi:[1,0,0]
    v_pk_fma_f16 v47, v47, v127, v55 op_sel:[1,1,0] op_sel_hi:[0,1,1] neg_hi:[1,0,0]
    s_nop 1
    v_mfma_f32_32x32x16_f16 v[92:107], v[136:139], v[44:47], v[92:107]
    v_cvt_pk_f16_f32 v48, v68, v84
    v_cvt_pk_f16_f32 v49, v69, v85
    v_cvt_pk_f16_f32 v50, v70, v86
    v_cvt_pk_f16_f32 v51, v71, v87
    v_pk_mul_f16 v52, v48, v128 op_sel_hi:[1,0]
    v_pk_mul_f16 v53, v49, v129 op_sel_hi:[1,0]
    v_pk_mul_f16 v54, v50, v130 op_sel_hi:[1,0]
    v_pk_mul_f16 v55, v51, v131 op_sel_hi:[1,0]
    v_pk_fma_f16 v48, v48, v128, v52 op_sel:[1,1,0] op_sel_hi:[0,1,1] neg_hi:[1,0,0]
    v_pk_fma_f16 v49, v49, v129, v53 op_sel:[1,1,0] op_sel_hi:[0,1,1] neg_hi:[1,0,0]
    v_pk_fma_f16 v50, v50, v130, v54 op_sel:[1,1,0] op_sel_hi:[0,1,1] neg_hi:[1,0,0]
    v_pk_fma_f16 v51, v51, v131, v55 op_sel:[1,1,0] op_sel_hi:[0,1,1] neg_hi:[1,0,0]
    s_nop 1
    v_mfma_f32_32x32x16_f16 v[92:107], v[140:143], v[48:51], v[92:107]
    s_nop 11
    v_cvt_pk_f16_f32 v76, v92, v93
    ds_write_b32 v153, v76 offset:0
    v_cvt_pk_f16_f32 v77, v94, v95
    ds_write_b32 v153, v77 offset:512
    v_cvt_pk_f16_f32 v78, v96, v97
    ds_write_b32 v153, v78 offset:2048
    v_cvt_pk_f16_f32 v79, v98, v99
    ds_write_b32 v153, v79 offset:2560
    v_cvt_pk_f16_f32 v80, v100, v101
    ds_write_b32 v153, v80 offset:4096
    v_cvt_pk_f16_f32 v81, v102, v103
    ds_write_b32 v153, v81 offset:4608
k_bar2:
    v_mov_b32 v3, 0
    s_waitcnt lgkmcnt(0)
    s_barrier
    ds_read_b128 v[40:43], v154
    ds_read_b128 v[56:59], v3 offset:43168
    s_cmp_lg_u32 s42, 8
    s_cbranch_scc1 k_nh0
    v_mul_u32_u24 v5, 2176, v0
    v_mov_b32 v4, s46
    s_lshl_b32 s43, s2, 3
    s_cmp_eq_u32 s2, 128
    s_cselect_b32 s43, 4, s43
    s_add_u32 s43, s43, 0x00009500
    s_mov_b64 exec, 0x000000ff
    buffer_store_dword v4, v5, s[28:31], s43 offen sc1
    s_mov_b64 exec, -1
k_nh0:
    s_mov_b32 s50, 0x00040004
    s_mov_b32 s51, 0xfff8fff8
    s_cmp_lg_u32 s42, 9
    s_cbranch_scc1 k_r1
    ds_read_b128 v[44:47], v154 offset:512
    s_add_u32 s44, s48, 16512
    s_waitcnt lgkmcnt(0)
    v_mfma_f32_16x16x32_f16 v[68:71], v[44:47], v[144:147], 0
    v_mfma_f32_16x16x32_f16 v[72:75], v[44:47], v[148:151], 0
    v_mfma_f32_16x16x32_f16 v[60:63], v[40:43], v[144:147], 0
    v_mfma_f32_16x16x32_f16 v[64:67], v[40:43], v[148:151], 0
    s_nop 5
    v_cvt_pk_f16_f32 v52, v68, v72
    v_cvt_pk_f16_f32 v53, v69, v73
    v_cvt_pk_f16_f32 v54, v70, v74
    v_cvt_pk_f16_f32 v55, v71, v75
    v_pk_add_u16 v52, v52, s50
    v_pk_add_u16 v53, v53, s50
    v_pk_add_u16 v54, v54, s50
    v_pk_add_u16 v55, v55, s50
    v_and_or_b32 v52, v52, s51, v56
    v_and_or_b32 v53, v53, s51, v57
    v_and_or_b32 v54, v54, s51, v58
    v_and_or_b32 v55, v55, s51, v59
    s_mov_b64 exec, 0xff
    buffer_store_dwordx4 v[52:55], v155, s[28:31], s44 offen sc1
    s_mov_b64 exec, -1
    s_branch k_r2
k_r1:
    s_waitcnt lgkmcnt(0)
    v_mfma_f32_16x16x32_f16 v[60:63], v[40:43], v[144:147], 0
    v_mfma_f32_16x16x32_f16 v[64:67], v[40:43], v[148:151], 0
k_r2:
    s_nop 7
    v_cvt_pk_f16_f32 v48, v60, v64
    v_cvt_pk_f16_f32 v49, v61, v65
    v_cvt_pk_f16_f32 v50, v62, v66
    v_cvt_pk_f16_f32 v51, v63, v67
    v_pk_add_u16 v48, v48, s50
    v_pk_add_u16 v49, v49, s50
    v_pk_add_u16 v50, v50, s50
    v_pk_add_u16 v51, v51, s50
    v_and_or_b32 v48, v48, s51, v56
    v_and_or_b32 v49, v49, s51, v57
    v_and_or_b32 v50, v50, s51, v58
    v_and_or_b32 v51, v51, s51, v59
    buffer_store_dwordx4 v[48:51], v155, s[28:31], s48 offen sc1
    s_cmp_ge_u32 s42, 8
    s_cbranch_scc1 k_hb3
    s_setprio 0
    ds_read_b32 v40, v3 offset:43144
    s_waitcnt vmcnt(1)
k_p2:
    ds_read_b128 v[8:11], v14 offset:44976
    ds_read_b64 v[6:7], v14 offset:46000
    s_and_b32 s67, s66, 15
    s_lshr_b32 s68, s66, 4
    s_and_b32 s43, s67, 7
    s_mul_i32 s43, s43, 11
    s_add_u32 s43, s43, s68
    s_mul_i32 s48, s43, 16512
    s_add_u32 s48, s48, 0x00060000
    s_cmp_eq_u32 s70, 0
    s_cselect_b64 s[40:41], 0, -1
    s_mov_b32 s49, 0x00001000
    v_xor_b32 v3, s54, v1
    v_add_u32 v3, s53, v3
    v_and_b32 v3, 31, v3
    v_lshl_add_u32 v3, v2, 5, v3
    s_lshl_b32 s43, s52, 12
    v_lshl_add_u32 v44, v3, 4, s43
    s_mul_i32 s43, s42, 2560
    s_add_u32 s43, s43, 22528
    s_waitcnt lgkmcnt(0)
    v_add_u32 v9, s43, v9
    v_add_u32 v10, s43, v10
    ds_write_b128 v9, v[156:159]
    ds_write_b128 v9, v[160:163] offset:1280
    ds_read_b128 v[148:151], v10
    ds_read_b128 v[152:155], v10 offset:16
    s_and_b32 s43, s42, 3
    s_and_b32 s44, s66, 15
    s_lshl4_add_u32 s44, s43, s44
    v_lshl_add_u32 v3, v1, 6, s44
    v_cvt_f32_u32 v100, v3
    s_and_b32 s44, s42, 4
    v_add_lshl_u32 v3, v2, s44, 2
    v_cvt_f32_u32 v101, v3
    v_mul_f32 v100, 0x3a000000, v100
    s_lshl_b32 s43, s43, 12
    s_lshl_b32 s44, s44, 9
    v_mul_f32 v101, v101, v100
    s_add_u32 s43, s43, s44
    v_cos_f32 v102, v101
    v_sin_f32 v4, v101
    v_fmamk_f32 v3, v100, 0x3f800000, v101
    v_cos_f32 v103, v3
    v_sin_f32 v5, v3
    v_cvt_pk_f16_f32 v92, v102, v4
    v_fmamk_f32 v3, v100, 0x40000000, v101
    v_cos_f32 v102, v3
    v_sin_f32 v4, v3
    v_cvt_pk_f16_f32 v93, v103, v5
    v_fmamk_f32 v3, v100, 0x40400000, v101
    v_cos_f32 v103, v3
    v_sin_f32 v5, v3
    v_cvt_pk_f16_f32 v94, v102, v4
    v_fmamk_f32 v3, v100, 0x41000000, v101
    v_cos_f32 v102, v3
    v_sin_f32 v4, v3
    v_cvt_pk_f16_f32 v95, v103, v5
    v_fmamk_f32 v3, v100, 0x41100000, v101
    v_cos_f32 v103, v3
    v_sin_f32 v5, v3
    v_cvt_pk_f16_f32 v96, v102, v4
    v_fmamk_f32 v3, v100, 0x41200000, v101
    v_cos_f32 v102, v3
    v_sin_f32 v4, v3
    v_cvt_pk_f16_f32 v97, v103, v5
    v_fmamk_f32 v3, v100, 0x41300000, v101
    v_cos_f32 v103, v3
    v_sin_f32 v5, v3
    v_cvt_pk_f16_f32 v98, v102, v4
    v_add_u32 v3, s43, v14
    v_cvt_pk_f16_f32 v99, v103, v5
    ds_write_b128 v3, v[92:95] offset:47024
    ds_write_b128 v3, v[96:99] offset:48048
    s_cmp_lt_u32 s2, 129
    s_cbranch_scc1 k_sl2
    s_waitcnt vmcnt(0)
k_sl2:
    buffer_load_dwordx2 v[166:167], v164, s[28:31], s49 offen sc1
    v_readfirstlane_b32 s46, v40
    v_cndmask_b32 v6, v6, v7, s[40:41]
    s_mul_i32 s43, s52, 4224
    s_add_u32 s43, s43, 63408
    v_add_u32 v6, s43, v6
    v_lshlrev_b32 v7, 3, v0
    s_lshl_b32 s43, s42, 9
    s_add_u32 s62, s48, s43
    s_add_u32 s63, s62, 4096
    s_add_u32 s64, s62, 8192
    s_add_u32 s65, s62, 12288
    s_add_u32 s48, s48, 16384
    s_mul_i32 s43, s42, 528
    s_add_u32 s43, s43, 63408
    v_add_u32 v11, s43, v11
    v_add_u32 v12, 4224, v11
    v_add_u32 v13, 8448, v11
    v_add_u32 v15, 12672, v11
    s_mov_b64 s[36:37], s[20:21]
    s_mov_b32 s38, 0x00280000
    s_mov_b32 s47, 0
    s_waitcnt lgkmcnt(0)
    v_lshlrev_b32 v108, 16, v148
    v_and_b32 v109, s45, v148
    v_lshlrev_b32 v110, 16, v149
    v_and_b32 v111, s45, v149
    v_lshlrev_b32 v112, 16, v150
    v_and_b32 v113, s45, v150
    v_lshlrev_b32 v114, 16, v151
    v_and_b32 v115, s45, v151
    v_lshlrev_b32 v116, 16, v152
    v_and_b32 v117, s45, v152
    v_lshlrev_b32 v118, 16, v153
    v_and_b32 v119, s45, v153
    v_lshlrev_b32 v120, 16, v154
    v_and_b32 v121, s45, v154
    v_lshlrev_b32 v122, 16, v155
    v_and_b32 v123, s45, v155
    s_waitcnt vmcnt(0)
k_spoll:
    v_cmp_ne_u32 vcc, s46, v167
    s_cbranch_vccz k_sgot
    s_sleep 3
    s_add_u32 s47, s47, 1
    s_and_b32 s44, s47, 15
    s_cbranch_scc1 nf1
    v_mov_b32 v4, 0
    global_load_dword v3, v4, s[16:17] sc1
    s_waitcnt vmcnt(0)
    v_readfirstlane_b32 s44, v3
    s_nop 3
    s_cmp_eq_u32 s44, 0
    s_cselect_b32 s46, s46, s44
nf1:
    s_cmp_lt_u32 s47, 131072
    s_cbranch_scc0 k_sgot
    buffer_load_dwordx2 v[166:167], v164, s[28:31], s49 offen sc1
    s_waitcnt vmcnt(0)
    s_branch k_spoll
k_sgot:
    s_bfe_u32 s56, s46, 0x30003
    s_bfe_u32 s44, s46, 0x30000
    s_pack_ll_b32_b16 s56, s44, s56
    s_xor_b32 s56, s56, 0x00050000
    s_bfe_u32 s57, s46, 0x30009
    s_bfe_u32 s44, s46, 0x30006
    s_pack_ll_b32_b16 s57, s44, s57
    s_xor_b32 s57, s57, 0x00030006
    s_bfe_u32 s58, s46, 0x3000f
    s_bfe_u32 s44, s46, 0x3000c
    s_pack_ll_b32_b16 s58, s44, s58
    s_xor_b32 s58, s58, 0x00060001
    s_bfe_u32 s59, s46, 0x30015
    s_bfe_u32 s44, s46, 0x30012
    s_pack_ll_b32_b16 s59, s44, s59
    s_xor_b32 s59, s59, 0x00010003
    v_lshlrev_b32 v3, 16, v166
    v_and_b32 v4, s45, v166
    v_rcp_f32 v3, v3
    v_and_b32 v5, 1, v0
    v_cmp_eq_u32 vcc, 0, v5
    v_mul_f32 v4, -v4, v3
    v_mov_b32 v42, s58
    v_mov_b32 v43, s59
    v_mov_b32 v24, s56
    v_mov_b32 v25, s57
    v_cndmask_b32 v42, v42, v24, vcc
    v_cndmask_b32 v43, v43, v25, vcc
    s_mov_b32 s47, 0
    s_waitcnt lgkmcnt(0)
    v_fma_f32 v76, v108, v3, v4
    v_fma_f32 v77, v109, v3, v4
    v_fma_f32 v78, v110, v3, v4
    v_fma_f32 v79, v111, v3, v4
    v_fma_f32 v80, v112, v3, v4
    v_fma_f32 v81, v113, v3, v4
    v_fma_f32 v82, v114, v3, v4
    v_fma_f32 v83, v115, v3, v4
    v_fma_f32 v84, v116, v3, v4
    v_fma_f32 v85, v117, v3, v4
    v_fma_f32 v86, v118, v3, v4
    v_fma_f32 v87, v119, v3, v4
    v_fma_f32 v88, v120, v3, v4
    v_fma_f32 v89, v121, v3, v4
    v_fma_f32 v90, v122, v3, v4
    v_fma_f32 v91, v123, v3, v4
    v_mul_f32 v60, 0xbfb8aa3b, v76
    v_mul_f32 v61, 0xbfb8aa3b, v77
    v_mul_f32 v62, 0xbfb8aa3b, v78
    v_mul_f32 v63, 0xbfb8aa3b, v79
    v_mul_f32 v64, 0xbfb8aa3b, v80
    v_mul_f32 v65, 0xbfb8aa3b, v81
    v_mul_f32 v66, 0xbfb8aa3b, v82
    v_mul_f32 v67, 0xbfb8aa3b, v83
    v_mul_f32 v68, 0xbfb8aa3b, v84
    v_mul_f32 v69, 0xbfb8aa3b, v85
    v_mul_f32 v70, 0xbfb8aa3b, v86
    v_mul_f32 v71, 0xbfb8aa3b, v87
    v_mul_f32 v72, 0xbfb8aa3b, v88
    v_mul_f32 v73, 0xbfb8aa3b, v89
    v_mul_f32 v74, 0xbfb8aa3b, v90
    v_mul_f32 v75, 0xbfb8aa3b, v91
    v_exp_f32 v60, v60
    v_exp_f32 v61, v61
    v_exp_f32 v62, v62
    v_exp_f32 v63, v63
    v_exp_f32 v64, v64
    v_exp_f32 v65, v65
    v_exp_f32 v66, v66
    v_exp_f32 v67, v67
    v_exp_f32 v68, v68
    v_exp_f32 v69, v69
    v_exp_f32 v70, v70
    v_exp_f32 v71, v71
    v_exp_f32 v72, v72
    v_exp_f32 v73, v73
    v_exp_f32 v74, v74
    v_exp_f32 v75, v75
    v_add_f32 v60, 1.0, v60
    v_add_f32 v61, 1.0, v61
    v_add_f32 v62, 1.0, v62
    v_add_f32 v63, 1.0, v63
    v_add_f32 v64, 1.0, v64
    v_add_f32 v65, 1.0, v65
    v_add_f32 v66, 1.0, v66
    v_add_f32 v67, 1.0, v67
    v_add_f32 v68, 1.0, v68
    v_add_f32 v69, 1.0, v69
    v_add_f32 v70, 1.0, v70
    v_add_f32 v71, 1.0, v71
    v_add_f32 v72, 1.0, v72
    v_add_f32 v73, 1.0, v73
    v_add_f32 v74, 1.0, v74
    v_add_f32 v75, 1.0, v75
    v_rcp_f32 v60, v60
    v_rcp_f32 v61, v61
    v_rcp_f32 v62, v62
    v_rcp_f32 v63, v63
    v_rcp_f32 v64, v64
    v_rcp_f32 v65, v65
    v_rcp_f32 v66, v66
    v_rcp_f32 v67, v67
    v_rcp_f32 v68, v68
    v_rcp_f32 v69, v69
    v_rcp_f32 v70, v70
    v_rcp_f32 v71, v71
    v_rcp_f32 v72, v72
    v_rcp_f32 v73, v73
    v_rcp_f32 v74, v74
    v_rcp_f32 v75, v75
    v_mul_f32 v60, v76, v60
    v_mul_f32 v61, v77, v61
    v_mul_f32 v62, v78, v62
    v_mul_f32 v63, v79, v63
    v_mul_f32 v64, v80, v64
    v_mul_f32 v65, v81, v65
    v_mul_f32 v66, v82, v66
    v_mul_f32 v67, v83, v67
    v_mul_f32 v68, v84, v68
    v_mul_f32 v69, v85, v69
    v_mul_f32 v70, v86, v70
    v_mul_f32 v71, v87, v71
    v_mul_f32 v72, v88, v72
    v_mul_f32 v73, v89, v73
    v_mul_f32 v74, v90, v74
    v_mul_f32 v75, v91, v75
    s_lshl_b32 s43, s42, 9
    s_add_u32 s43, s43, 80304
    v_add_u32 v3, s43, v7
    v_mov_b32 v24, v42
    v_mov_b32 v25, v43
    v_mov_b32 v40, 0
    s_cmp_lg_u32 s42, 0
    s_barrier
    ds_read_b64 v[16:17], v3 offset:0
    ds_read_b64 v[18:19], v3 offset:4096
    ds_read_b64 v[20:21], v3 offset:8192
    ds_read_b64 v[22:23], v3 offset:12288
    s_cbranch_scc1 k_vc0
    s_mov_b64 exec, 0xffff
    ds_read_b64 v[24:25], v3 offset:16384
    s_mov_b64 exec, -1
k_vc0:
    ds_read_b128 v[92:95], v44 offset:47024
    ds_read_b128 v[96:99], v44 offset:48048
    ds_read_b128 v[100:103], v44 offset:49072
    ds_read_b128 v[104:107], v44 offset:50096
    ds_read_b64 v[166:167], v40 offset:43136
k_vck:
    s_waitcnt vmcnt(0) lgkmcnt(5)
    v_xor_b32 v16, v16, v42
    v_xor_b32 v17, v17, v43
    v_xor_b32 v18, v18, v42
    v_xor_b32 v19, v19, v43
    v_xor_b32 v20, v20, v42
    v_xor_b32 v21, v21, v43
    v_xor_b32 v22, v22, v42
    v_xor_b32 v23, v23, v43
    v_xor_b32 v24, v24, v42
    v_xor_b32 v25, v25, v43
    v_or3_b32 v3, v16, v17, v18
    v_or3_b32 v4, v19, v20, v21
    v_or3_b32 v3, v3, v22, v23
    v_or3_b32 v4, v4, v24, v25
    v_or_b32 v3, v3, v4
    v_and_b32 v3, 0x00070007, v3
    v_cmp_ne_u32 vcc, 0, v3
    s_cbranch_vccnz k_vre
k_vok:
    s_mov_b32 s43, 0x39a839a8
    s_bitcmp1_b32 s67, 3
    s_cbranch_scc1 k_oddc
    v_pk_add_f16 v16, v16, v24
    v_pk_add_f16 v36, v18, v22
    v_pk_add_f16 v37, v18, v22 neg_lo:[0,1] neg_hi:[0,1]
    v_pk_add_f16 v34, v16, v20
    v_pk_add_f16 v35, v16, v20 neg_lo:[0,1] neg_hi:[0,1]
    v_pk_add_f16 v26, v34, v36
    v_pk_add_f16 v30, v34, v36 neg_lo:[0,1] neg_hi:[0,1]
    v_pk_add_f16 v28, v35, v37 op_sel:[0,1] op_sel_hi:[1,0] neg_hi:[0,1]
    v_pk_add_f16 v32, v35, v37 op_sel:[0,1] op_sel_hi:[1,0] neg_lo:[0,1]
    v_pk_add_f16 v17, v17, v25
    v_pk_add_f16 v36, v19, v23
    v_pk_add_f16 v37, v19, v23 neg_lo:[0,1] neg_hi:[0,1]
    v_pk_add_f16 v34, v17, v21
    v_pk_add_f16 v35, v17, v21 neg_lo:[0,1] neg_hi:[0,1]
    v_pk_add_f16 v27, v34, v36
    v_pk_add_f16 v31, v34, v36 neg_lo:[0,1] neg_hi:[0,1]
    v_pk_add_f16 v29, v35, v37 op_sel:[0,1] op_sel_hi:[1,0] neg_hi:[0,1]
    v_pk_add_f16 v33, v35, v37 op_sel:[0,1] op_sel_hi:[1,0] neg_lo:[0,1]
    s_branch k_bfdc
k_oddc:
    v_pk_add_f16 v16, v16, v24 neg_lo:[0,1] neg_hi:[0,1]
    v_pk_add_f16 v36, v18, v22 op_sel:[0,1] op_sel_hi:[1,0] neg_hi:[0,1]
    v_pk_add_f16 v37, v18, v22 op_sel:[0,1] op_sel_hi:[1,0] neg_lo:[0,1]
    v_pk_add_f16 v34, v16, v20 op_sel:[0,1] op_sel_hi:[1,0] neg_hi:[0,1]
    v_pk_add_f16 v35, v16, v20 op_sel:[0,1] op_sel_hi:[1,0] neg_lo:[0,1]
    v_pk_add_f16 v36, v36, v36 op_sel:[0,1] op_sel_hi:[1,0] neg_hi:[0,1]
    v_pk_add_f16 v37, v37, v37 op_sel:[0,1] op_sel_hi:[1,0] neg_hi:[0,1]
    v_pk_fma_f16 v26, v36, s43, v34
    v_pk_fma_f16 v30, v36, s43, v34 neg_lo:[1,0,0] neg_hi:[1,0,0]
    v_pk_fma_f16 v28, v37, s43, v35 op_sel:[1,0,0] op_sel_hi:[0,1,1] neg_hi:[1,0,0]
    v_pk_fma_f16 v32, v37, s43, v35 op_sel:[1,0,0] op_sel_hi:[0,1,1] neg_lo:[1,0,0]
    v_pk_add_f16 v17, v17, v25 neg_lo:[0,1] neg_hi:[0,1]
    v_pk_add_f16 v36, v19, v23 op_sel:[0,1] op_sel_hi:[1,0] neg_hi:[0,1]
    v_pk_add_f16 v37, v19, v23 op_sel:[0,1] op_sel_hi:[1,0] neg_lo:[0,1]
    v_pk_add_f16 v34, v17, v21 op_sel:[0,1] op_sel_hi:[1,0] neg_hi:[0,1]
    v_pk_add_f16 v35, v17, v21 op_sel:[0,1] op_sel_hi:[1,0] neg_lo:[0,1]
    v_pk_add_f16 v36, v36, v36 op_sel:[0,1] op_sel_hi:[1,0] neg_hi:[0,1]
    v_pk_add_f16 v37, v37, v37 op_sel:[0,1] op_sel_hi:[1,0] neg_hi:[0,1]
    v_pk_fma_f16 v27, v36, s43, v34
    v_pk_fma_f16 v31, v36, s43, v34 neg_lo:[1,0,0] neg_hi:[1,0,0]
    v_pk_fma_f16 v29, v37, s43, v35 op_sel:[1,0,0] op_sel_hi:[0,1,1] neg_hi:[1,0,0]
    v_pk_fma_f16 v33, v37, s43, v35 op_sel:[1,0,0] op_sel_hi:[0,1,1] neg_lo:[1,0,0]
k_bfdc:
    ds_write2_b32 v11, v26, v27 offset0:0 offset1:4
    ds_write2_b32 v12, v28, v29 offset0:0 offset1:4
    ds_write2_b32 v13, v30, v31 offset0:0 offset1:4
    ds_write2_b32 v15, v32, v33 offset0:0 offset1:4
    s_mov_b64 s[52:53], -1
    s_mov_b64 s[54:55], -1
    s_waitcnt lgkmcnt(0)
    s_barrier
    ds_read_b128 v[124:127], v6 offset:0
    ds_read_b128 v[128:131], v6 offset:1056
    ds_read_b128 v[132:135], v6 offset:2112
    ds_read_b128 v[136:139], v6 offset:3168
    v_readfirstlane_b32 s22, v166
    v_readfirstlane_b32 s23, v167
    s_and_b32 s43, s22, 63
    s_and_b32 s44, s23, 63
    s_waitcnt lgkmcnt(3)
    v_mfma_f32_32x32x16_f16 v[76:91], v[124:127], v[92:95], 0
    s_waitcnt lgkmcnt(2)
    v_mfma_f32_32x32x16_f16 v[76:91], v[128:131], v[96:99], v[76:91]
    s_waitcnt lgkmcnt(1)
    v_mfma_f32_32x32x16_f16 v[76:91], v[132:135], v[100:103], v[76:91]
    s_waitcnt lgkmcnt(0)
    v_mfma_f32_32x32x16_f16 v[76:91], v[136:139], v[104:107], v[76:91]
    s_cmp_eq_u32 s43, s69
    s_cbranch_scc1 k_fix0
k_fix0r:
    s_cmp_eq_u32 s44, s69
    s_cbranch_scc1 k_fix1
k_fix1r:
    s_nop 7
    v_fma_f32 v60, v76, v60, v108
    v_fma_f32 v61, v77, v61, v109
    v_fma_f32 v62, v78, v62, v110
    v_fma_f32 v63, v79, v63, v111
    v_fma_f32 v64, v80, v64, v112
    v_fma_f32 v65, v81, v65, v113
    v_fma_f32 v66, v82, v66, v114
    v_fma_f32 v67, v83, v67, v115
    v_cvt_pk_bf16_f32 v140, v60, v61
    v_cvt_pk_bf16_f32 v141, v62, v63
    v_cvt_pk_bf16_f32 v142, v64, v65
    v_cvt_pk_bf16_f32 v143, v66, v67
    ds_write_b128 v10, v[140:143] offset:0
    v_fma_f32 v68, v84, v68, v116
    v_fma_f32 v69, v85, v69, v117
    v_fma_f32 v70, v86, v70, v118
    v_fma_f32 v71, v87, v71, v119
    v_fma_f32 v72, v88, v72, v120
    v_fma_f32 v73, v89, v73, v121
    v_fma_f32 v74, v90, v74, v122
    v_fma_f32 v75, v91, v75, v123
    v_cvt_pk_bf16_f32 v144, v68, v69
    v_cvt_pk_bf16_f32 v145, v70, v71
    v_cvt_pk_bf16_f32 v146, v72, v73
    v_cvt_pk_bf16_f32 v147, v74, v75
    ds_write_b128 v10, v[144:147] offset:16
    ds_read_b128 v[148:151], v9
    ds_read_b128 v[152:155], v9 offset:1280
    s_waitcnt lgkmcnt(1)
    s_mov_b64 exec, s[52:53]
    buffer_store_dwordx4 v[148:151], v8, s[36:39], s60 offen sc1
    s_waitcnt lgkmcnt(0)
    s_mov_b64 exec, s[54:55]
    buffer_store_dwordx4 v[152:155], v8, s[36:39], s61 offen sc1
    s_endpgm
k_vre:
    s_add_u32 s47, s47, 1
    s_cmp_ge_u32 s47, 131072
    s_cbranch_scc1 k_vok
    s_sleep 2
    buffer_load_dwordx2 v[16:17], v7, s[28:31], s62 offen sc1
    buffer_load_dwordx2 v[18:19], v7, s[28:31], s63 offen sc1
    buffer_load_dwordx2 v[20:21], v7, s[28:31], s64 offen sc1
    buffer_load_dwordx2 v[22:23], v7, s[28:31], s65 offen sc1
    v_mov_b32 v24, v42
    v_mov_b32 v25, v43
    s_cmp_lg_u32 s42, 0
    s_cbranch_scc1 vb2
    s_mov_b64 exec, 0xffff
    buffer_load_dwordx2 v[24:25], v7, s[28:31], s48 offen sc1
    s_mov_b64 exec, -1
vb2:
    s_branch k_vck
k_fix0:
    s_lshl_b32 s43, s70, 2
    v_mov_b32 v5, s43
    s_lshl_b32 s43, s70, 7
    v_lshl_add_u32 v3, v2, 6, s43
    s_bfe_u32 s43, s22, 0x50006
    s_lshl_b32 s43, 1, s43
    v_mov_b32 v4, 1
    s_mov_b32 exec_lo, s43
    s_mov_b32 exec_hi, s43
    s_nop 0
    ds_write_b128 v3, v[76:79] offset:43184
    ds_write_b128 v3, v[80:83] offset:43200
    ds_write_b128 v3, v[84:87] offset:43216
    ds_write_b128 v3, v[88:91] offset:43232
    ds_write_b32 v5, v4 offset:43152
    s_mov_b64 exec, -1
    s_bfe_u32 s43, s22, 0x40006
    s_lshl_b32 s43, s43, 2
    s_lshl_b64 s[40:41], 15, s43
    s_bitcmp1_b32 s22, 10
    s_cbranch_scc1 k_fixb0
    s_andn2_b64 s[52:53], s[52:53], s[40:41]
    s_branch k_fix0r
k_fixb0:
    s_andn2_b64 s[54:55], s[54:55], s[40:41]
    s_branch k_fix0r
k_fix1:
    s_lshl_b32 s43, s70, 2
    v_mov_b32 v5, s43
    s_lshl_b32 s43, s70, 7
    v_lshl_add_u32 v3, v2, 6, s43
    s_bfe_u32 s43, s23, 0x50006
    s_lshl_b32 s43, 1, s43
    v_mov_b32 v4, 1
    s_mov_b32 exec_lo, s43
    s_mov_b32 exec_hi, s43
    ds_write_b128 v3, v[76:79] offset:43440
    ds_write_b128 v3, v[80:83] offset:43456
    ds_write_b128 v3, v[84:87] offset:43472
    ds_write_b128 v3, v[88:91] offset:43488
    ds_write_b32 v5, v4 offset:43160
    s_mov_b64 exec, -1
    s_bfe_u32 s43, s23, 0x40006
    s_lshl_b32 s43, s43, 2
    s_lshl_b64 s[40:41], 15, s43
    s_bitcmp1_b32 s23, 10
    s_cbranch_scc1 k_fixb1
    s_andn2_b64 s[52:53], s[52:53], s[40:41]
    s_branch k_fix1r
k_fixb1:
    s_andn2_b64 s[54:55], s[54:55], s[40:41]
    s_branch k_fix1r
k_helper:
    v_bfrev_b32 v164, 2
    s_mov_b32 s55, 0
    s_cmp_eq_u32 s42, 8
    s_cbranch_scc1 k_h8
    v_and_b32 v3, 7, v0
    v_cvt_f32_u32 v62, v3
    v_and_b32 v3, 16, v0
    s_lshr_b32 s43, s2, 5
    v_lshl_add_u32 v3, v3, 1, s43
    v_cvt_f32_u32 v61, v3
    v_mul_f32 v60, 0x3e000000, v62
    v_mul_f32 v61, v61, v62
    v_mul_f32 v61, 0x3c800000, v61
    v_cos_f32 v64, v61
    v_sin_f32 v68, v61
    v_add_f32 v61, v61, v60
    v_cos_f32 v65, v61
    v_sin_f32 v69, v61
    v_add_f32 v61, v61, v60
    v_cos_f32 v66, v61
    v_sin_f32 v70, v61
    v_add_f32 v61, v61, v60
    v_cos_f32 v67, v61
    v_sin_f32 v71, v61
    v_bfe_u32 v3, v0, 3, 1
    v_cmp_eq_u32 vcc, v3, v2
    s_and_b32 s43, s2, 127
    s_cselect_b32 s43, 1.0, 0.5
    v_mov_b32 v3, s43
    v_cndmask_b32 v3, 0, v3, vcc
    v_mul_f32 v64, v64, v3
    v_mul_f32 v68, v68, v3
    v_mul_f32 v65, v65, v3
    v_mul_f32 v69, v69, v3
    v_mul_f32 v66, v66, v3
    v_mul_f32 v70, v70, v3
    v_mul_f32 v67, v67, v3
    v_mul_f32 v71, v71, v3
    v_cvt_pk_f16_f32 v144, v64, v68
    v_cvt_pk_f16_f32 v148, -v68, v64
    v_cvt_pk_f16_f32 v145, v65, v69
    v_cvt_pk_f16_f32 v149, -v69, v65
    v_cvt_pk_f16_f32 v146, v66, v70
    v_cvt_pk_f16_f32 v150, -v70, v66
    v_cvt_pk_f16_f32 v147, v67, v71
    v_cvt_pk_f16_f32 v151, -v71, v67
    ds_write_b128 v14, v[144:147] offset:35840
    ds_write_b128 v14, v[148:151] offset:36864
    v_lshrrev_b32 v3, 2, v0
    v_and_b32 v4, 3, v0
    v_mul_u32_u24 v16, 81920, v3
    v_lshl_add_u32 v16, v4, 4, v16
    v_mul_u32_u24 v17, 80, v3
    v_lshl_add_u32 v17, v4, 4, v17
    v_mul_u32_u24 v18, 80, v1
    v_lshl_add_u32 v18, v2, 5, v18
    v_lshrrev_b32 v3, 3, v1
    v_lshl_add_u32 v3, v3, 2, v4
    v_and_b32 v4, 4, v0
    v_lshl_add_u32 v3, v4, 2, v3
    v_mul_u32_u24 v4, 33, v2
    v_add_lshl_u32 v20, v4, v3, 4
    v_sub_u32 v3, 32, v3
    v_add_lshl_u32 v21, v4, v3, 4
    v_and_b32 v3, 15, v0
    v_lshlrev_b32 v3, 5, v3
    v_lshrrev_b32 v4, 4, v0
    v_lshl_add_u32 v19, v4, 2, v3
    ds_write_b128 v14, v[16:19] offset:44976
    ds_write_b64 v14, v[20:21] offset:46000
    s_waitcnt lgkmcnt(0)
    s_mov_b64 s[24:25], s[4:5]
    s_mov_b64 s[28:29], s[18:19]
    s_barrier
    ds_read_b128 v[152:155], v14 offset:37888
    s_add_u32 s3, s2, 7
    s_and_b32 s3, s3, 7
    s_mul_i32 s3, s3, 7
    s_min_u32 s3, s3, 48
    s_cmp_ge_u32 s2, 128
    s_cbranch_scc1 k_h9d
    s_mov_b64 s[32:33], s[10:11]
    s_mov_b32 s34, 2211840
    s_lshr_b32 s43, s2, 3
    s_mul_i32 s43, s43, 69120
    s_lshl_b32 s44, s3, 6
    s_add_u32 s43, s43, s44
    v_mul_u32_u24 v3, 3456, v2
    v_lshl_add_u32 v3, v1, 4, v3
    s_cmp_lt_u32 s3, 42
    s_cselect_b32 s47, 28, 24
    v_cmp_gt_u32 vcc, s47, v1
    v_bfrev_b32 v4, 2
    s_nop 0
    v_cndmask_b32 v3, v4, v3, vcc
    buffer_load_dwordx4 v[96:99], v3, s[32:35], s43 offen
    s_addk_i32 s43, 6912
    buffer_load_dwordx4 v[100:103], v3, s[32:35], s43 offen
    s_addk_i32 s43, 6912
    buffer_load_dwordx4 v[104:107], v3, s[32:35], s43 offen
    s_addk_i32 s43, 6912
    buffer_load_dwordx4 v[108:111], v3, s[32:35], s43 offen
    s_addk_i32 s43, 6912
    buffer_load_dwordx4 v[112:115], v3, s[32:35], s43 offen
    s_addk_i32 s43, 6912
    buffer_load_dwordx4 v[116:119], v3, s[32:35], s43 offen
    s_addk_i32 s43, 6912
    buffer_load_dwordx4 v[120:123], v3, s[32:35], s43 offen
    s_addk_i32 s43, 6912
    buffer_load_dwordx4 v[124:127], v3, s[32:35], s43 offen
    s_addk_i32 s43, 6912
    buffer_load_dwordx4 v[96:99], v3, s[32:35], s43 offen
    s_addk_i32 s43, 6912
    buffer_load_dwordx4 v[100:103], v3, s[32:35], s43 offen
    s_addk_i32 s43, 6912
    s_mov_b64 s[32:33], s[12:13]
    s_lshr_b32 s43, s2, 3
    s_mul_i32 s43, s43, 34560
    s_add_u32 s43, s43, s44
    s_add_u32 s43, s43, 1658880
    buffer_load_dwordx4 v[96:99], v3, s[32:35], s43 offen
    s_addk_i32 s43, 6912
    buffer_load_dwordx4 v[100:103], v3, s[32:35], s43 offen
    s_addk_i32 s43, 6912
    buffer_load_dwordx4 v[104:107], v3, s[32:35], s43 offen
    s_addk_i32 s43, 6912
    buffer_load_dwordx4 v[108:111], v3, s[32:35], s43 offen
    s_addk_i32 s43, 6912
    buffer_load_dwordx4 v[112:115], v3, s[32:35], s43 offen
    s_addk_i32 s43, 6912
k_h9d:
    s_waitcnt lgkmcnt(0)
    s_lshl_b32 s43, s42, 9
    v_add_u32 v154, s43, v154
    s_mul_i32 s48, s42, 16512
    s_lshl_b32 s44, s2, 7
    s_add_u32 s48, s48, s44
    s_add_u32 s48, s48, 0x00060000
    s_branch k_bar2
k_h8:
    v_bfe_u32 v3, v0, 2, 2
    v_lshl_add_u32 v3, v2, 3, v3
    v_and_b32 v4, 19, v0
    v_mul_u32_u24 v3, 40, v3
    v_min_u32 v4, 4, v4
    v_lshl_add_u32 v152, v4, 3, v3
    s_movk_i32 s43, 10240
    v_lshl_add_u32 v3, v2, 6, v1
    v_lshl_add_u32 v153, v3, 4, s43
    v_and_b32 v3, 16, v0
    v_mul_u32_u24 v154, 384, v3
    v_and_b32 v5, 15, v0
    v_lshl_add_u32 v3, v2, 4, v5
    v_lshl_add_u32 v154, v3, 4, v154
    v_add_u32 v154, s43, v154
    v_and_b32 v3, 7, v0
    v_mul_u32_u24 v155, 181632, v3
    v_and_b32 v3, 8, v0
    v_lshl_add_u32 v155, v3, 3, v155
    v_and_b32 v3, 48, v0
    v_add_u32 v155, v155, v3
    ds_write_b128 v14, v[152:155] offset:37888
    v_mov_b32 v18, 0
    v_lshlrev_b32 v3, 2, v1
    ds_write_b32 v3, v18 offset:43008
    s_waitcnt lgkmcnt(0)
    s_load_dword s46, s[18:19], 0x00000000
    s_mov_b64 s[24:25], s[4:5]
    s_mov_b64 s[28:29], s[18:19]
    s_lshl_b32 s43, s42, 9
    v_add_u32 v154, s43, v154
    s_mul_i32 s48, s42, 16512
    s_lshl_b32 s44, s2, 7
    s_add_u32 s48, s48, s44
    s_add_u32 s48, s48, 0x00060000
    v_lshlrev_b32 v26, 3, v5
    v_lshrrev_b32 v3, 1, v5
    v_lshl_add_u32 v27, v3, 8, s2
    v_sub_u32 v3, 2048, v27
    v_and_b32 v3, 2047, v3
    v_and_b32 v4, 1, v0
    v_cmp_eq_u32 vcc, 0, v4
    s_and_b32 s43, s2, 127
    s_cselect_b32 s43, s45, 0
    v_cndmask_b32 v27, v3, v27, vcc
    v_mov_b32 v3, s43
    v_mov_b32 v4, s45
    v_cndmask_b32 v28, v3, v4, vcc
    v_mul_u32_u24 v30, 2176, v0
    v_mov_b32 v38, 0
    s_mov_b32 s47, 0x3f803f80
    s_lshl_b32 s43, s2, 4
    s_add_u32 s43, s43, 0x00005100
    s_mul_i32 s44, s2, 128
    s_add_u32 s44, s44, 0x00001000
    s_barrier
    ds_read_b64 v[32:33], v6 offset:43696
    ds_read_b64 v[34:35], v6 offset:44208
    ds_read_b32 v36, v7 offset:44720
    ds_read_b128 v[144:147], v14 offset:35840
    ds_read_b128 v[148:151], v14 offset:36864
    s_waitcnt lgkmcnt(0)
    v_dot2c_f32_bf16 v38, s47, v32
    v_dot2c_f32_bf16 v38, s47, v33
    v_dot2c_f32_bf16 v38, s47, v34
    v_dot2c_f32_bf16 v38, s47, v35
    v_dot2c_f32_bf16 v38, s47, v36
    s_add_u32 s46, s46, 1
    s_or_b32 s46, s46, 0x80000000
    v_mov_b32 v17, s46
    v_mov_b32 v19, s46
    v_mov_b32 v23, s46
    v_add_f32_dpp v38, v38, v38 quad_perm:[1,0,3,2] row_mask:0xf bank_mask:0xf
    s_nop 1
    v_add_f32_dpp v38, v38, v38 quad_perm:[2,3,0,1] row_mask:0xf bank_mask:0xf
    s_nop 1
    v_add_f32_dpp v38, v38, v38 row_half_mirror row_mask:0xf bank_mask:0xf
    s_nop 1
    v_add_f32_dpp v38, v38, v38 row_mirror row_mask:0xf bank_mask:0xf
    s_nop 1
    v_add_f32_dpp v38, v38, v38 row_bcast:15 row_mask:0xa bank_mask:0xf
    s_nop 1
    v_add_f32_dpp v38, v38, v38 row_bcast:31 row_mask:0xc bank_mask:0xf
    s_nop 0
    v_readlane_b32 s65, v38, 63
    ds_write_b32 v18, v17 offset:43144
k_kpoll:
    ds_read_b64 v[20:21], v26 offset:43008
    s_waitcnt lgkmcnt(0)
    v_cmp_eq_u32 vcc, 0, v21
    s_cbranch_vccnz k_kpoll
    v_lshlrev_b32 v3, 16, v21
    v_and_b32 v4, s45, v21
    v_rcp_f32 v3, v3
    v_fma_f32 v16, -v4, s65, v20
    v_mul_f32 v16, v16, v3
    v_cvt_pk_bf16_f32 v16, v16, v16
    v_ashrrev_i32 v4, 31, v16
    v_or_b32 v4, 0x80000000, v4
    v_xor_b32 v16, v16, v4
    v_and_or_b32 v16, v16, v28, v27
    v_mov_b32 v22, v21
    s_nop 0
    v_mov_b32_dpp v3, v16 quad_perm:[1,0,3,2] row_mask:0xf bank_mask:0xf
    v_max_u32_dpp v18, v18, v18 quad_perm:[1,0,3,2] row_mask:0xf bank_mask:0xf
    v_med3_u32 v18, v16, v3, v18
    v_max_u32 v16, v16, v3
    s_nop 1
    v_mov_b32_dpp v3, v16 quad_perm:[2,3,0,1] row_mask:0xf bank_mask:0xf
    v_max_u32_dpp v18, v18, v18 quad_perm:[2,3,0,1] row_mask:0xf bank_mask:0xf
    v_med3_u32 v18, v16, v3, v18
    v_max_u32 v16, v16, v3
    s_nop 1
    v_mov_b32_dpp v3, v16 row_half_mirror row_mask:0xf bank_mask:0xf
    v_max_u32_dpp v18, v18, v18 row_half_mirror row_mask:0xf bank_mask:0xf
    v_med3_u32 v18, v16, v3, v18
    v_max_u32 v16, v16, v3
    s_nop 1
    v_mov_b32_dpp v3, v16 row_mirror row_mask:0xf bank_mask:0xf
    v_max_u32_dpp v18, v18, v18 row_mirror row_mask:0xf bank_mask:0xf
    v_med3_u32 v18, v16, v3, v18
    v_max_u32 v16, v16, v3
    s_mov_b64 exec, 0x000000ff
    buffer_store_dwordx4 v[16:19], v30, s[28:31], s43 offen sc1
    s_mov_b64 exec, 0xffff
    buffer_store_dwordx2 v[22:23], v26, s[28:31], s44 offen sc1
    s_mov_b64 exec, -1
    s_bfe_u32 s50, s46, 0x30003
    s_bfe_u32 s44, s46, 0x30000
    s_pack_ll_b32_b16 s50, s44, s50
    s_xor_b32 s50, s50, 0x00050000
    s_bfe_u32 s51, s46, 0x30009
    s_bfe_u32 s44, s46, 0x30006
    s_pack_ll_b32_b16 s51, s44, s51
    s_xor_b32 s51, s51, 0x00030006
    s_bfe_u32 s52, s46, 0x3000f
    s_bfe_u32 s44, s46, 0x3000c
    s_pack_ll_b32_b16 s52, s44, s52
    s_xor_b32 s52, s52, 0x00060001
    s_bfe_u32 s53, s46, 0x30015
    s_bfe_u32 s44, s46, 0x30012
    s_pack_ll_b32_b16 s53, s44, s53
    s_xor_b32 s53, s53, 0x00010003
    v_mov_b32 v40, s50
    v_mov_b32 v41, s51
    v_mov_b32 v42, s52
    v_mov_b32 v43, s53
    v_mov_b32 v3, 0
    ds_write_b128 v3, v[40:43] offset:43168
    s_branch k_bar2
k_hb3:
    s_cmp_eq_u32 s42, 8
    s_cbranch_scc1 k_h8p
    v_mov_b32 v3, 0
    ds_read_b32 v3, v3 offset:43144
    s_waitcnt lgkmcnt(0)
    v_readfirstlane_b32 s46, v3
    s_branch k_h9p
k_h8p:
    s_and_b32 s67, s66, 15
    s_lshr_b32 s68, s66, 4
    s_and_b32 s43, s67, 7
    s_mul_i32 s43, s43, 11
    s_add_u32 s43, s43, s68
    s_mul_i32 s48, s43, 16512
    s_add_u32 s48, s48, 0x00060000
    s_mov_b32 s49, s48
    s_add_u32 s62, s48, 16512
    s_add_u32 s63, s62, 4096
    s_add_u32 s64, s62, 8192
    s_add_u32 s65, s62, 12288
    s_add_u32 s48, s62, 16384
    v_lshrrev_b32 v3, 2, v1
    v_mul_u32_u24 v44, 528, v3
    v_and_b32 v3, 3, v0
    v_lshl_add_u32 v44, v3, 2, v44
    v_add_u32 v44, 63408, v44
    s_mov_b32 s47, 0
    v_lshlrev_b32 v46, 7, v0
    v_lshlrev_b32 v50, 4, v0
    v_lshlrev_b32 v5, 24, v0
    v_cmp_eq_u32 vcc, 0, v0
    s_lshr_b32 s43, s2, 0
    s_and_b32 s43, s43, 7
    v_cndmask_b32 v49, 0, -1, vcc
    s_mul_i32 s43, s43, 2176
    s_add_u32 s54, s43, 0x00009500
    s_waitcnt vmcnt(0)
k_flp:
    buffer_load_dwordx4 v[52:55], v50, s[28:31], s54 offen sc1
    s_waitcnt vmcnt(0)
    v_xor_b32 v45, s46, v52
    v_xor_b32 v47, s46, v54
    v_xor_b32 v48, s46, v53
    v_and_b32 v48, v48, v49
    v_or3_b32 v3, v45, v47, v48
    v_cmp_ne_u32 vcc, 0, v3
    s_cbranch_vccz k_flg
    s_add_u32 s47, s47, 1
    s_and_b32 s44, s47, 15
    s_cbranch_scc1 nf3
    v_mov_b32 v4, 0
    global_load_dword v3, v4, s[16:17] sc1
    s_waitcnt vmcnt(0)
    v_readfirstlane_b32 s44, v3
    s_nop 3
    s_cmp_eq_u32 s44, 0
    s_cselect_b32 s46, s46, s44
nf3:
    s_cmp_lt_u32 s47, 131072
    s_cbranch_scc1 k_flp
k_flg:
    s_mov_b64 exec, -1
    s_mov_b32 m0, 80304
    s_nop 0
    buffer_load_dwordx4 v50, s[28:31], s49 offen offset:0 sc1 lds
    buffer_load_dwordx4 v50, s[28:31], s49 offen offset:1024 sc1 lds
    buffer_load_dwordx4 v50, s[28:31], s49 offen offset:2048 sc1 lds
    buffer_load_dwordx4 v50, s[28:31], s49 offen offset:3072 sc1 lds
    s_add_u32 m0, m0, 4096
    s_addk_i32 s49, 4096
    buffer_load_dwordx4 v50, s[28:31], s49 offen offset:0 sc1 lds
    buffer_load_dwordx4 v50, s[28:31], s49 offen offset:1024 sc1 lds
    buffer_load_dwordx4 v50, s[28:31], s49 offen offset:2048 sc1 lds
    buffer_load_dwordx4 v50, s[28:31], s49 offen offset:3072 sc1 lds
    s_add_u32 m0, m0, 4096
    s_addk_i32 s49, 4096
    buffer_load_dwordx4 v50, s[28:31], s49 offen offset:0 sc1 lds
    buffer_load_dwordx4 v50, s[28:31], s49 offen offset:1024 sc1 lds
    buffer_load_dwordx4 v50, s[28:31], s49 offen offset:2048 sc1 lds
    buffer_load_dwordx4 v50, s[28:31], s49 offen offset:3072 sc1 lds
    s_add_u32 m0, m0, 4096
    s_addk_i32 s49, 4096
    buffer_load_dwordx4 v50, s[28:31], s49 offen offset:0 sc1 lds
    buffer_load_dwordx4 v50, s[28:31], s49 offen offset:1024 sc1 lds
    buffer_load_dwordx4 v50, s[28:31], s49 offen offset:2048 sc1 lds
    buffer_load_dwordx4 v50, s[28:31], s49 offen offset:3072 sc1 lds
    s_add_u32 m0, m0, 4096
    s_addk_i32 s49, 4096
    s_mov_b64 exec, 0xff
    buffer_load_dwordx4 v50, s[28:31], s49 offen offset:0 sc1 lds
    s_mov_b32 s47, 0
    s_mov_b32 exec_lo, -1
k_hld:
    s_bfe_u32 s50, s46, 0x30003
    s_bfe_u32 s44, s46, 0x30000
    s_pack_ll_b32_b16 s50, s44, s50
    s_xor_b32 s50, s50, 0x00050000
    s_bfe_u32 s51, s46, 0x30009
    s_bfe_u32 s44, s46, 0x30006
    s_pack_ll_b32_b16 s51, s44, s51
    s_xor_b32 s51, s51, 0x00030006
    s_bfe_u32 s52, s46, 0x3000f
    s_bfe_u32 s44, s46, 0x3000c
    s_pack_ll_b32_b16 s52, s44, s52
    s_xor_b32 s52, s52, 0x00060001
    s_bfe_u32 s53, s46, 0x30015
    s_bfe_u32 s44, s46, 0x30012
    s_pack_ll_b32_b16 s53, s44, s53
    s_xor_b32 s53, s53, 0x00010003
    v_mov_b32 v32, s50
    v_mov_b32 v33, s51
    v_mov_b32 v34, s52
    v_mov_b32 v35, s53
    buffer_load_dwordx4 v[16:19], v46, s[28:31], s62 offen sc1
    buffer_load_dwordx4 v[20:23], v46, s[28:31], s63 offen sc1
    buffer_load_dwordx4 v[24:27], v46, s[28:31], s64 offen sc1
    buffer_load_dwordx4 v[28:31], v46, s[28:31], s65 offen sc1
    s_mov_b32 exec_lo, 1
    buffer_load_dwordx4 v[32:35], v46, s[28:31], s48 offen sc1
    s_mov_b32 exec_lo, -1
    s_cmp_lg_u32 s47, 0
    s_cbranch_scc1 k_hl2
    s_waitcnt vmcnt(5)
    s_barrier
    v_mov_b32 v3, 0
    ds_read_b64 v[94:95], v3 offset:43136
k_hl2:
    s_waitcnt vmcnt(0)
k_hl3:
    v_xor_b32 v16, s50, v16
    v_xor_b32 v17, s51, v17
    v_xor_b32 v18, s52, v18
    v_xor_b32 v19, s53, v19
    v_xor_b32 v20, s50, v20
    v_xor_b32 v21, s51, v21
    v_xor_b32 v22, s52, v22
    v_xor_b32 v23, s53, v23
    v_xor_b32 v24, s50, v24
    v_xor_b32 v25, s51, v25
    v_xor_b32 v26, s52, v26
    v_xor_b32 v27, s53, v27
    v_xor_b32 v28, s50, v28
    v_xor_b32 v29, s51, v29
    v_xor_b32 v30, s52, v30
    v_xor_b32 v31, s53, v31
    v_xor_b32 v32, s50, v32
    v_xor_b32 v33, s51, v33
    v_xor_b32 v34, s52, v34
    v_xor_b32 v35, s53, v35
    v_or_b32 v3, v16, v17
    v_or3_b32 v3, v3, v18, v19
    v_or3_b32 v3, v3, v20, v21
    v_or3_b32 v3, v3, v22, v23
    v_or3_b32 v3, v3, v24, v25
    v_or3_b32 v3, v3, v26, v27
    v_or3_b32 v3, v3, v28, v29
    v_or3_b32 v3, v3, v30, v31
    v_or3_b32 v3, v3, v32, v33
    v_or3_b32 v3, v3, v34, v35
    v_and_b32 v3, 0x00070007, v3
    v_cmp_ne_u32 vcc, 0, v3
    s_cbranch_vccz k_hok
    s_sleep 2
    s_add_u32 s47, s47, 1
    s_and_b32 s44, s47, 15
    s_cbranch_scc1 nf4
    v_mov_b32 v4, 0
    global_load_dword v3, v4, s[16:17] sc1
    s_waitcnt vmcnt(0)
    v_readfirstlane_b32 s44, v3
    s_nop 3
    s_cmp_eq_u32 s44, 0
    s_cselect_b32 s46, s46, s44
nf4:
    s_cmp_lt_u32 s47, 131072
    s_cbranch_scc1 k_hld
k_hok:
    s_mov_b32 s43, 0x39a839a8
    s_bitcmp1_b32 s67, 3
    s_cbranch_scc1 k_oddh
    v_pk_add_f16 v16, v16, v32
    v_pk_add_f16 v42, v20, v28
    v_pk_add_f16 v43, v20, v28 neg_lo:[0,1] neg_hi:[0,1]
    v_pk_add_f16 v40, v16, v24
    v_pk_add_f16 v41, v16, v24 neg_lo:[0,1] neg_hi:[0,1]
    v_pk_add_f16 v36, v40, v42
    v_pk_add_f16 v38, v40, v42 neg_lo:[0,1] neg_hi:[0,1]
    v_pk_add_f16 v37, v41, v43 op_sel:[0,1] op_sel_hi:[1,0] neg_hi:[0,1]
    v_pk_add_f16 v39, v41, v43 op_sel:[0,1] op_sel_hi:[1,0] neg_lo:[0,1]
    s_branch k_bfdh
k_oddh:
    v_pk_add_f16 v16, v16, v32 neg_lo:[0,1] neg_hi:[0,1]
    v_pk_add_f16 v42, v20, v28 op_sel:[0,1] op_sel_hi:[1,0] neg_hi:[0,1]
    v_pk_add_f16 v43, v20, v28 op_sel:[0,1] op_sel_hi:[1,0] neg_lo:[0,1]
    v_pk_add_f16 v40, v16, v24 op_sel:[0,1] op_sel_hi:[1,0] neg_hi:[0,1]
    v_pk_add_f16 v41, v16, v24 op_sel:[0,1] op_sel_hi:[1,0] neg_lo:[0,1]
    v_pk_add_f16 v42, v42, v42 op_sel:[0,1] op_sel_hi:[1,0] neg_hi:[0,1]
    v_pk_add_f16 v43, v43, v43 op_sel:[0,1] op_sel_hi:[1,0] neg_hi:[0,1]
    v_pk_fma_f16 v36, v42, s43, v40
    v_pk_fma_f16 v38, v42, s43, v40 neg_lo:[1,0,0] neg_hi:[1,0,0]
    v_pk_fma_f16 v37, v43, s43, v41 op_sel:[1,0,0] op_sel_hi:[0,1,1] neg_hi:[1,0,0]
    v_pk_fma_f16 v39, v43, s43, v41 op_sel:[1,0,0] op_sel_hi:[0,1,1] neg_lo:[1,0,0]
k_bfdh:
    ds_write_b32 v44, v36 offset:512
    ds_write_b32 v44, v37 offset:4736
    ds_write_b32 v44, v38 offset:8960
    ds_write_b32 v44, v39 offset:13184
    s_waitcnt vmcnt(0) lgkmcnt(0)
    s_barrier
    v_readfirstlane_b32 s22, v94
    v_readfirstlane_b32 s23, v95
    s_mov_b64 exec, -1
    s_mov_b32 s52, 0
    s_and_b32 s67, s66, 15
    s_sub_u32 s44, 16, s67
    s_and_b32 s44, s44, 15
    s_mov_b32 s50, 0
    s_and_b32 s43, s22, 15
    s_cmp_eq_u32 s43, s67
    s_cselect_b32 s51, 1, 0
    s_or_b32 s50, s50, s51
    s_cmp_eq_u32 s43, s44
    s_cselect_b32 s51, 2, 0
    s_or_b32 s50, s50, s51
    s_and_b32 s43, s23, 15
    s_cmp_eq_u32 s43, s67
    s_cselect_b32 s51, 4, 0
    s_or_b32 s50, s50, s51
    s_cmp_eq_u32 s43, s44
    s_cselect_b32 s51, 8, 0
    s_or_b32 s50, s50, s51
    s_mov_b32 s44, 0
    s_sub_u32 s43, 0, s50
    s_and_b32 s43, s43, s50
    s_xor_b32 s50, s50, s43
    s_sub_u32 s43, 0, s50
    s_and_b32 s43, s43, s50
    s_xor_b32 s50, s50, s43
    s_or_b32 s44, s44, s43
    s_sub_u32 s43, 0, s50
    s_and_b32 s43, s43, s50
    s_xor_b32 s50, s50, s43
    s_sub_u32 s43, 0, s50
    s_and_b32 s43, s43, s50
    s_xor_b32 s50, s50, s43
    s_or_b32 s44, s44, s43
    s_or_b32 s50, s44, 0
    s_cbranch_scc1 k_part
    s_endpgm
k_h9p:
    s_lshr_b32 s49, s2, 3
    v_lshlrev_b32 v31, 4, v0
    s_and_b32 s43, s49, 7
    s_mul_i32 s43, s43, 2176
    s_add_u32 s54, s43, 0x00005100
    s_add_u32 s55, s54, 1024
    s_add_u32 s59, s54, 2048
    s_setprio 3
    s_mov_b32 s47, 0
    v_lshlrev_b32 v5, 24, v0
    v_cmp_eq_u32 vcc, 0, v0
    s_nop 1
    v_cndmask_b32 v28, 0, -1, vcc
k_hpoll:
    buffer_load_dwordx4 v[16:19], v31, s[28:31], s54 offen sc1
    buffer_load_dwordx4 v[20:23], v31, s[28:31], s55 offen sc1
    buffer_load_dwordx4 v[24:27], v5, s[28:31], s59 offen sc1
k_hchk:
    s_waitcnt vmcnt(0)
    v_xor_b32 v17, s46, v17
    v_xor_b32 v19, s46, v19
    v_xor_b32 v21, s46, v21
    v_xor_b32 v23, s46, v23
    v_xor_b32 v25, s46, v25
    v_xor_b32 v27, s46, v27
    v_or3_b32 v3, v17, v19, v21
    v_or_b32 v4, v25, v27
    v_and_or_b32 v4, v4, v28, v23
    v_or_b32 v3, v3, v4
    v_max3_u32 v29, v16, v20, v24
    v_cmp_ne_u32 vcc, 0, v3
    s_cbranch_vccz k_hgot
    s_mov_b64 exec, vcc
    s_add_u32 s47, s47, 1
    s_and_b32 s44, s47, 15
    s_cbranch_scc1 nf5
    v_mov_b32 v4, 0
    global_load_dword v3, v4, s[16:17] sc1
    s_waitcnt vmcnt(0)
    v_readfirstlane_b32 s44, v3
    s_nop 3
    s_cmp_eq_u32 s44, 0
    s_cselect_b32 s46, s46, s44
nf5:
    s_cmp_lt_u32 s47, 131072
    s_cbranch_scc1 k_hpoll
k_hgot:
    s_setprio 3
    s_mov_b64 exec, -1
    v_max_u32_dpp v3, v29, v29 quad_perm:[1,0,3,2] row_mask:0xf bank_mask:0xf
    v_med3_u32 v30, v16, v20, v24
    v_max3_u32 v4, v18, v22, v26
    v_max_u32_dpp v3, v3, v3 quad_perm:[2,3,0,1] row_mask:0xf bank_mask:0xf
    v_max_u32 v30, v30, v4
    v_lshlrev_b32 v31, 4, v0
    v_max_u32_dpp v3, v3, v3 row_half_mirror row_mask:0xf bank_mask:0xf
    v_lshlrev_b32 v28, 2, v0
    s_nop 0
    v_max_u32_dpp v3, v3, v3 row_mirror row_mask:0xf bank_mask:0xf
    s_nop 1
    v_max_u32_dpp v3, v3, v3 row_bcast:15 row_mask:0xa bank_mask:0xf
    s_nop 1
    v_max_u32_dpp v3, v3, v3 row_bcast:31 row_mask:0xc bank_mask:0xf
    s_nop 0
    v_readlane_b32 s22, v3, 63
    s_nop 1
    v_cmp_eq_u32 vcc, s22, v29
    s_nop 1
    v_cndmask_b32 v3, v29, v30, vcc
    s_nop 1
    v_max_u32_dpp v3, v3, v3 quad_perm:[1,0,3,2] row_mask:0xf bank_mask:0xf
    s_nop 1
    v_max_u32_dpp v3, v3, v3 quad_perm:[2,3,0,1] row_mask:0xf bank_mask:0xf
    s_nop 1
    v_max_u32_dpp v3, v3, v3 row_half_mirror row_mask:0xf bank_mask:0xf
    s_nop 1
    v_max_u32_dpp v3, v3, v3 row_mirror row_mask:0xf bank_mask:0xf
    s_nop 1
    v_max_u32_dpp v3, v3, v3 row_bcast:15 row_mask:0xa bank_mask:0xf
    s_nop 1
    v_max_u32_dpp v3, v3, v3 row_bcast:31 row_mask:0xc bank_mask:0xf
    s_nop 0
    v_readlane_b32 s23, v3, 63
    v_mov_b32 v16, s22
    s_nop 0
    v_mov_b32 v17, s23
    v_mov_b32 v5, 0
    ds_write_b64 v5, v[16:17] offset:43136
    v_mov_b32 v52, 0
    v_mov_b32 v53, 0
    v_mov_b32 v54, 0
    v_mov_b32 v55, 0
    ds_write_b128 v5, v[52:55] offset:43152
    s_and_b32 s67, s66, 15
    s_sub_u32 s44, 16, s67
    s_and_b32 s44, s44, 15
    s_mov_b32 s50, 0
    s_and_b32 s43, s22, 15
    s_cmp_eq_u32 s43, s67
    s_cselect_b32 s51, 1, 0
    s_or_b32 s50, s50, s51
    s_cmp_eq_u32 s43, s44
    s_cselect_b32 s51, 2, 0
    s_or_b32 s50, s50, s51
    s_and_b32 s43, s23, 15
    s_cmp_eq_u32 s43, s67
    s_cselect_b32 s51, 4, 0
    s_or_b32 s50, s50, s51
    s_cmp_eq_u32 s43, s44
    s_cselect_b32 s51, 8, 0
    s_or_b32 s50, s50, s51
    s_mov_b32 s44, 0
    s_sub_u32 s43, 0, s50
    s_and_b32 s43, s43, s50
    s_xor_b32 s50, s50, s43
    s_or_b32 s44, s44, s43
    s_sub_u32 s43, 0, s50
    s_and_b32 s43, s43, s50
    s_xor_b32 s50, s50, s43
    s_sub_u32 s43, 0, s50
    s_and_b32 s43, s43, s50
    s_xor_b32 s50, s50, s43
    s_or_b32 s44, s44, s43
    s_sub_u32 s43, 0, s50
    s_and_b32 s43, s43, s50
    s_xor_b32 s50, s50, s43
    s_or_b32 s50, s44, 0
    s_mov_b32 s52, 1
    s_waitcnt lgkmcnt(0)
    s_cbranch_scc1 k_part
    s_endpgm
k_part:
    s_lshr_b32 s68, s66, 4
    s_mov_b64 s[36:37], s[20:21]
    s_mov_b32 s38, 0x00280000
    v_lshlrev_b32 v47, 4, v0
    v_and_b32 v3, 7, v0
    v_lshlrev_b32 v4, 1, v2
    v_lshl_add_u32 v50, v3, 2, v4
    v_bfe_u32 v3, v0, 4, 1
    v_add_u32 v50, v50, v3
    v_mov_b32 v76, 0
    v_mov_b32 v77, s46
    v_mov_b32 v78, 0
    v_mov_b32 v79, s46
k_pnext:
    s_ff1_i32_b32 s51, s50
    s_bitset0_b32 s50, s51
    s_sub_u32 s44, 19, s68
    s_bitcmp1_b32 s51, 0
    s_cselect_b32 s43, s44, s68
    v_lshl_add_u32 v3, s43, 5, v50
    s_lshr_b32 s44, s51, 1
    s_cselect_b32 s53, s23, s22
    s_mul_i32 s44, s44, 20
    s_add_u32 s43, s43, s44
    s_mul_i32 s43, s43, 6912
    s_add_u32 s56, s43, 0x0000e000
    s_add_u32 s57, s56, 4096
    v_lshlrev_b32 v88, 1, v3
    s_and_b32 s43, s53, 2047
    s_mul_i32 s58, s43, 1280
    buffer_load_ushort v48, v88, s[24:27], s58 offen
    s_mov_b32 s55, 0x00001000
    v_mov_b32 v3, s53
    v_and_b32 v49, 2047, v3
    v_sub_u32 v4, 2048, v49
    v_and_b32 v5, 255, v49
    v_cmp_lt_u32 vcc, 128, v5
    s_nop 1
    v_cndmask_b32 v4, v49, v4, vcc
    v_cndmask_b32 v51, 0, 8, vcc
    v_and_b32 v5, 255, v4
    v_lshrrev_b32 v4, 8, v4
    v_mul_u32_u24 v5, 128, v5
    v_add_u32 v51, v5, v51
    v_lshl_add_u32 v51, v4, 4, v51
    v_ashrrev_i32 v4, 31, v3
    v_not_b32 v4, v4
    v_or_b32 v4, 0x80000000, v4
    v_xor_b32 v3, v3, v4
    v_and_b32 v3, s45, v3
    v_mul_f32 v3, 0xbfb8aa3b, v3
    v_exp_f32 v3, v3
    s_nop 0
    v_add_f32 v3, 1.0, v3
    v_rcp_f32 v49, v3
    s_mov_b32 s47, 0
    s_cmp_eq_u32 s52, 0
    s_cbranch_scc1 k_pr0
    s_barrier
    s_barrier
    s_mov_b32 s52, 0
k_pr0:
    s_lshl_b32 s43, s51, 7
    v_lshl_add_u32 v46, v50, 2, s43
    s_lshl_b32 s43, s51, 2
    v_mov_b32 v92, s43
k_yw:
    ds_read_b32 v91, v92 offset:43152
    ds_read_b32 v90, v46 offset:43184
    s_waitcnt lgkmcnt(0)
    v_cmp_eq_u32 vcc, 0, v91
    s_cbranch_vccnz k_yw
k_pr:
    buffer_load_dwordx2 v[80:81], v51, s[28:31], s55 offen sc1
    buffer_load_dwordx4 v[52:55], v47, s[28:31], s56 offen offset:0 sc1
    buffer_load_dwordx4 v[56:59], v47, s[28:31], s56 offen offset:1024 sc1
    buffer_load_dwordx4 v[60:63], v47, s[28:31], s56 offen offset:2048 sc1
    buffer_load_dwordx4 v[64:67], v47, s[28:31], s56 offen offset:3072 sc1
    buffer_load_dwordx4 v[68:71], v47, s[28:31], s57 offen offset:0 sc1
    buffer_load_dwordx4 v[72:75], v47, s[28:31], s57 offen offset:1024 sc1
    s_mov_b32 s44, exec_hi
    s_and_b32 exec_hi, exec_hi, 0xffff
    s_cbranch_execz k_pr6
    buffer_load_dwordx4 v[76:79], v47, s[28:31], s57 offen offset:2048 sc1
k_pr6:
    s_mov_b32 exec_hi, s44
    s_waitcnt vmcnt(0)
    v_bitop3_b32 v3, v81, v53, v55 bitop3:0x80
    v_or3_b32 v5, v81, v53, v55
    v_bitop3_b32 v3, v3, v57, v59 bitop3:0x80
    v_or3_b32 v5, v5, v57, v59
    v_bitop3_b32 v3, v3, v61, v63 bitop3:0x80
    v_or3_b32 v5, v5, v61, v63
    v_bitop3_b32 v3, v3, v65, v67 bitop3:0x80
    v_or3_b32 v5, v5, v65, v67
    v_bitop3_b32 v3, v3, v69, v71 bitop3:0x80
    v_or3_b32 v5, v5, v69, v71
    v_bitop3_b32 v3, v3, v73, v75 bitop3:0x80
    v_or3_b32 v5, v5, v73, v75
    v_bitop3_b32 v3, v3, v77, v79 bitop3:0x80
    v_or3_b32 v5, v5, v77, v79
    v_xor_b32 v3, s46, v3
    v_xor_b32 v5, s46, v5
    v_or_b32 v3, v3, v5
    v_cmp_ne_u32 vcc, 0, v3
    s_cbranch_vccz k_pg
    s_mov_b64 exec, vcc
    s_add_u32 s47, s47, 1
    s_cmp_lt_u32 s47, 131072
    s_cbranch_scc1 k_pr
k_pg:
    s_mov_b64 exec, -1
    s_mov_b32 s43, 0x00003f80
    s_mov_b32 s44, 0x3f800000
    v_mov_b32 v84, 0
    v_mov_b32 v85, 0
    v_mov_b32 v86, 0
    v_mov_b32 v87, 0
    v_dot2c_f32_bf16 v84, s43, v52
    v_dot2c_f32_bf16 v85, s44, v52
    v_dot2c_f32_bf16 v86, s43, v54
    v_dot2c_f32_bf16 v87, s44, v54
    v_dot2c_f32_bf16 v84, s43, v56
    v_dot2c_f32_bf16 v85, s44, v56
    v_dot2c_f32_bf16 v86, s43, v58
    v_dot2c_f32_bf16 v87, s44, v58
    v_dot2c_f32_bf16 v84, s43, v60
    v_dot2c_f32_bf16 v85, s44, v60
    v_dot2c_f32_bf16 v86, s43, v62
    v_dot2c_f32_bf16 v87, s44, v62
    v_dot2c_f32_bf16 v84, s43, v64
    v_dot2c_f32_bf16 v85, s44, v64
    v_dot2c_f32_bf16 v86, s43, v66
    v_dot2c_f32_bf16 v87, s44, v66
    v_dot2c_f32_bf16 v84, s43, v68
    v_dot2c_f32_bf16 v85, s44, v68
    v_dot2c_f32_bf16 v86, s43, v70
    v_dot2c_f32_bf16 v87, s44, v70
    v_dot2c_f32_bf16 v84, s43, v72
    v_dot2c_f32_bf16 v85, s44, v72
    v_dot2c_f32_bf16 v86, s43, v74
    v_dot2c_f32_bf16 v87, s44, v74
    v_dot2c_f32_bf16 v84, s43, v76
    v_dot2c_f32_bf16 v85, s44, v76
    v_dot2c_f32_bf16 v86, s43, v78
    v_dot2c_f32_bf16 v87, s44, v78
    v_lshlrev_b32 v5, 16, v80
    v_lshlrev_b32 v48, 16, v48
    v_and_b32 v4, s45, v80
    v_permlane32_swap_b32 v84, v86
    v_permlane32_swap_b32 v85, v87
    v_add_f32 v84, v84, v86
    v_add_f32 v85, v85, v87
    v_rcp_f32 v5, v5
    v_sub_f32 v89, v48, v4
    v_permlane16_swap_b32 v84, v85
    v_add_f32 v3, v84, v85
    v_mul_f32 v89, v89, v5
    s_waitcnt lgkmcnt(0)
    v_add_f32_dpp v3, v3, v3 row_ror:8 row_mask:0xf bank_mask:0xf
    v_fma_f32 v3, v3, v49, v89
    v_mul_f32 v4, 0xbfb8aa3b, v3
    v_exp_f32 v4, v4
    s_nop 0
    v_add_f32 v4, 1.0, v4
    v_rcp_f32 v4, v4
    s_nop 0
    v_mul_f32 v3, v3, v4
    v_fma_f32 v3, v90, v3, v48
    v_cvt_pk_bf16_f32 v3, v3, v3
    s_mov_b32 exec_lo, 0x00ff00ff
    s_mov_b32 exec_hi, 0x00ff00ff
    buffer_store_short v3, v88, s[36:39], s58 offen
    s_mov_b64 exec, -1
    s_cmp_lg_u32 s50, 0
    s_cbranch_scc1 k_pnext
    s_endpgm
k_other:
    s_add_u32 s3, s2, 7
    s_and_b32 s3, s3, 7
    s_mul_i32 s3, s3, 7
    s_min_u32 s3, s3, 48
    s_sub_u32 s66, s2, 54
    s_sub_u32 s43, s2, 184
    s_lshr_b32 s43, s43, 3
    s_mul_i32 s43, s43, 10
    s_add_u32 s43, s43, s42
    s_lshl_b32 s44, s3, 6
    s_mul_i32 s48, s43, 20736
    s_add_u32 s48, s48, s44
    s_mul_i32 s49, s3, 40960
    s_lshl_b32 s43, s43, 12
    s_add_u32 s49, s49, s43
    v_mul_u32_u24 v5, 3456, v2
    v_lshl_add_u32 v5, v1, 4, v5
    s_cmp_lt_u32 s3, 42
    s_cselect_b32 s47, 28, 24
    v_cmp_gt_u32 vcc, s47, v1
    v_bfrev_b32 v4, 2
    s_nop 0
    v_cndmask_b32 v5, v4, v5, vcc
    v_lshlrev_b32 v14, 4, v0
    s_mov_b32 s34, 2211840
    s_mov_b32 s38, 2211840
    s_mul_i32 s38, s47, 10240
    s_mul_i32 s44, s3, 40960
    s_add_u32 s38, s38, s44
    s_waitcnt lgkmcnt(0)
    s_load_dword s46, s[18:19], 0x00000000
    s_mov_b64 s[24:25], s[4:5]
    s_mov_b64 s[28:29], s[18:19]
    s_sub_u32 s44, s2, 248
    s_cmp_ge_u32 s44, 8
    s_cbranch_scc1 k_ntch
    s_cmp_ge_u32 s42, 6
    s_cbranch_scc1 k_ntch
    s_lshl3_add_u32 s44, s42, s44
    s_lshl_b32 s44, s44, 13
    v_lshlrev_b32 v4, 7, v0
    s_cmp_ge_u32 s44, 333824
    s_cbranch_scc1 k_ntch
    buffer_load_dword v90, v4, s[28:31], s44 offen
k_ntch:
    s_cmp_ge_u32 s66, 160
    s_cbranch_scc1 k_nox
    s_cmp_ge_u32 s42, 8
    s_cbranch_scc1 k_nox
    s_and_b32 s67, s66, 15
    s_lshr_b32 s68, s66, 4
    s_and_b32 s52, s42, 3
    s_lshr_b32 s70, s42, 2
    s_lshl4_add_u32 s69, s52, s67
    s_sub_u32 s43, 64, s69
    s_and_b32 s43, s43, 63
    s_cselect_b32 s53, 32, 33
    s_lshl_b32 s44, s68, 6
    s_sub_u32 s61, 1216, s44
    s_cmp_eq_u32 s70, 0
    s_cselect_b32 s69, s69, s43
    s_cselect_b32 s44, s44, s61
    s_cselect_b32 s53, 0, s53
    s_cselect_b32 s54, 0, -1
    s_mul_i32 s43, s69, 1280
    s_add_u32 s60, s43, s44
    s_add_u32 s61, s60, 1310720
    v_lshrrev_b32 v3, 2, v0
    v_and_b32 v4, 3, v0
    v_mul_u32_u24 v3, 81920, v3
    v_lshl_add_u32 v3, v4, 4, v3
    buffer_load_dwordx4 v[156:159], v3, s[24:27], s60 offen
    buffer_load_dwordx4 v[160:163], v3, s[24:27], s61 offen
k_nox:
    s_waitcnt lgkmcnt(0)
    s_sub_u32 s43, s2, 184
    s_mov_b64 s[36:37], s[14:15]
    s_cmp_lt_u32 s43, 64
    s_cbranch_scc1 k_dopf
    s_mov_b32 s38, 0
    s_mov_b32 s49, 0
    s_branch k_nopf0
k_dopf:
    s_mov_b64 s[32:33], s[12:13]
    buffer_load_dwordx4 v[60:63], v5, s[32:35], s48 offen
    s_addk_i32 s48, 6912
    buffer_load_dwordx4 v[64:67], v5, s[32:35], s48 offen
    s_addk_i32 s48, 6912
    buffer_load_dwordx4 v[68:71], v5, s[32:35], s48 offen
    s_addk_i32 s48, 6912
k_nopf0:
    s_waitcnt vmcnt(0)
    buffer_load_dwordx4 v[76:79], v14, s[36:39], s49 offen offset:0
    buffer_load_dwordx4 v[80:83], v14, s[36:39], s49 offen offset:1024
    buffer_load_dwordx4 v[84:87], v14, s[36:39], s49 offen offset:2048
    buffer_load_dwordx4 v[88:91], v14, s[36:39], s49 offen offset:3072
k_nopf:
    s_waitcnt lgkmcnt(0)
    s_add_u32 s46, s46, 1
    s_or_b32 s46, s46, 0x80000000
    s_cmp_ge_u32 s66, 160
    s_cbranch_scc1 k_end
    s_cmp_ge_u32 s42, 8
    s_cbranch_scc1 k_oh
    v_mov_b32 v40, s46
    v_lshl_add_u32 v3, v1, 6, s69
    v_sub_u32 v4, 2048, v3
    v_and_b32 v5, 255, v3
    v_cmp_lt_u32 vcc, 128, v5
    s_nop 1
    v_cndmask_b32 v4, v3, v4, vcc
    v_cndmask_b32 v164, 0, 8, vcc
    v_and_b32 v5, 255, v4
    v_lshrrev_b32 v4, 8, v4
    v_mul_u32_u24 v5, 128, v5
    v_add_u32 v164, v5, v164
    v_lshl_add_u32 v164, v4, 4, v164
    s_mov_b32 s49, 0x00001000
    s_barrier
    s_branch k_p2
k_oh:
    s_setprio 3
    s_cmp_eq_u32 s42, 9
    s_cbranch_scc1 k_oh9
    v_lshrrev_b32 v3, 2, v0
    v_and_b32 v4, 3, v0
    v_mul_u32_u24 v16, 81920, v3
    v_lshl_add_u32 v16, v4, 4, v16
    v_mul_u32_u24 v17, 80, v3
    v_lshl_add_u32 v17, v4, 4, v17
    v_mul_u32_u24 v18, 80, v1
    v_lshl_add_u32 v18, v2, 5, v18
    v_lshrrev_b32 v3, 3, v1
    v_lshl_add_u32 v3, v3, 2, v4
    v_and_b32 v4, 4, v0
    v_lshl_add_u32 v3, v4, 2, v3
    v_mul_u32_u24 v4, 33, v2
    v_add_lshl_u32 v20, v4, v3, 4
    v_sub_u32 v3, 32, v3
    v_add_lshl_u32 v21, v4, v3, 4
    v_and_b32 v3, 15, v0
    v_lshlrev_b32 v3, 5, v3
    v_lshrrev_b32 v4, 4, v0
    v_lshl_add_u32 v19, v4, 2, v3
    ds_write_b128 v14, v[16:19] offset:44976
    ds_write_b64 v14, v[20:21] offset:46000
    s_waitcnt lgkmcnt(0)
    s_barrier
    s_branch k_h8p
k_oh9:
    s_barrier
    s_waitcnt vmcnt(0)
    s_branch k_h9p
k_ffn:
    s_add_u32 s3, s2, 7
    s_and_b32 s3, s3, 7
    s_mul_i32 s3, s3, 7
    s_min_u32 s3, s3, 48
    s_cmp_ge_u32 s42, 5
    s_cselect_b32 s65, 5, 0
    s_sub_u32 s49, s42, s65
    s_lshr_b32 s43, s43, 3
    s_add_u32 s48, s3, s43
    v_and_b32 v6, 15, v0
    v_lshrrev_b32 v7, 4, v0
    v_mul_u32_u24 v12, 10240, v7
    s_mul_i32 s43, s48, 40960
    s_lshl_b32 s44, s49, 8
    s_add_u32 s43, s43, s44
    v_lshl_add_u32 v3, v6, 4, s43
    v_add_u32 v12, v12, v3
    s_movk_i32 s56, 5120
    s_mov_b32 s38, 2211840
    s_sub_u32 s43, s48, s3
    s_cmp_eq_u32 s43, 6
    s_cselect_b32 s43, 0, s43
    s_mul_i32 s43, s43, 10
    s_add_u32 s43, s43, s42
    s_mul_i32 s43, s43, 20736
    s_min_u32 s43, s43, 1085184
    s_lshl_b32 s44, s3, 6
    s_add_u32 s43, s43, s44
    s_add_u32 s43, s43, 1105920
    v_mul_u32_u24 v5, 3456, v2
    v_lshl_add_u32 v5, v1, 4, v5
    s_cmp_lt_u32 s3, 42
    s_cselect_b32 s47, 28, 24
    v_cmp_gt_u32 vcc, s47, v1
    v_bfrev_b32 v4, 2
    s_nop 0
    v_cndmask_b32 v5, v4, v5, vcc
    s_mov_b32 s34, 2211840
    s_waitcnt lgkmcnt(0)
    s_load_dword s46, s[18:19], 0x00000000
    s_mov_b64 s[24:25], s[4:5]
    s_mov_b64 s[28:29], s[18:19]
    s_mov_b64 s[32:33], s[10:11]
    s_mov_b64 s[36:37], s[14:15]
    s_waitcnt lgkmcnt(0)
    buffer_load_dwordx4 v[24:27], v5, s[32:35], s43 offen
    s_addk_i32 s43, 6912
    buffer_load_dwordx4 v[28:31], v5, s[32:35], s43 offen
    s_addk_i32 s43, 6912
    buffer_load_dwordx4 v[32:35], v5, s[32:35], s43 offen
    s_addk_i32 s43, 6912
    s_cmp_eq_u32 s65, 0
    s_cselect_b64 s[32:33], s[10:11], s[12:13]
    v_mov_b32 v9, 0
    v_and_b32 v3, 12, v6
    v_add_u32 v3, v3, v7
    s_lshl_b32 s43, s49, 4
    v_add_u32 v3, s43, v3
    v_mul_u32_u24 v11, 27648, v3
    v_and_b32 v3, 3, v6
    s_lshl_b32 s43, s48, 6
    v_lshl_add_u32 v4, v3, 4, s43
    v_add_u32 v11, v11, v4
    s_movk_i32 s51, 6912
    s_movk_i32 s52, 13824
    s_movk_i32 s53, 20736
    s_mov_b32 s62, 0x05040100
    s_mov_b32 s63, 0x07060302
    v_lshlrev_b32 v3, 6, v3
    v_lshl_add_u32 v3, v7, 4, v3
    v_and_b32 v4, 4, v6
    v_mul_u32_u24 v4, 320, v4
    s_lshl_b32 s43, s49, 8
    v_add3_u32 v13, v3, v4, s43
    v_mul_u32_u24 v14, 48, v0
    s_lshl_b32 s43, s42, 2
    v_add_u32 v14, s43, v14
    v_and_b32 v3, 4, v6
    v_lshlrev_b32 v3, 4, v3
    v_and_b32 v4, 3, v6
    v_lshl_add_u32 v3, v4, 2, v3
    v_add_u32 v3, v3, v7
    v_mul_u32_u24 v17, 48, v3
    v_and_b32 v18, 8, v6
    v_mul_u32_u24 v3, 96, v18
    v_add_u32 v15, v17, v3
    v_and_b32 v3, 1, v6
    v_cmp_eq_u32 vcc, 0, v3
    v_mov_b32 v4, 0xffff
    v_mov_b32 v5, s45
    v_cndmask_b32 v4, v5, v4, vcc
    v_bfe_u32 v3, v6, 1, 2
    v_cmp_eq_u32 vcc, 0, v3
    v_mov_b32 v120, 0x3f803f80
    s_nop 0
    v_cndmask_b32 v20, 0, v4, vcc
    v_cmp_eq_u32 vcc, 1, v3
    v_mov_b32 v121, 0x3f803f80
    s_nop 0
    v_cndmask_b32 v21, 0, v4, vcc
    v_cmp_eq_u32 vcc, 2, v3
    v_mov_b32 v122, 0x3f803f80
    s_nop 0
    v_cndmask_b32 v22, 0, v4, vcc
    v_cmp_eq_u32 vcc, 3, v3
    v_mov_b32 v123, 0x3f803f80
    s_nop 0
    v_cndmask_b32 v23, 0, v4, vcc
    v_mov_b32 v20, v4
    v_and_b32 v21, 16, v0
    v_lshrrev_b32 v3, 2, v6
    v_mad_u32_u24 v3, v2, 20, v3
    v_mul_u32_u24 v16, 6912, v3
    v_and_b32 v3, 3, v6
    v_lshl_add_u32 v16, v3, 5, v16
    v_and_b32 v3, 16, v0
    v_add_u32 v16, v16, v3
    s_lshl_b32 s43, s48, 7
    s_mul_i32 s44, s49, 27648
    s_add_u32 s57, s43, s44
    s_add_u32 s57, s57, 0x0000e000
    s_waitcnt vmcnt(0)
    s_barrier
    buffer_load_dwordx4 v[24:27], v11, s[32:35], 0 offen offset:0
    buffer_load_dwordx4 v[28:31], v11, s[32:35], 0 offen offset:3456
    buffer_load_dwordx4 v[32:35], v11, s[32:35], s51 offen offset:0
    buffer_load_dwordx4 v[36:39], v11, s[32:35], s51 offen offset:3456
    buffer_load_dwordx4 v[40:43], v11, s[32:35], s52 offen offset:0
    buffer_load_dwordx4 v[44:47], v11, s[32:35], s52 offen offset:3456
    buffer_load_dwordx4 v[48:51], v11, s[32:35], s53 offen offset:0
    buffer_load_dwordx4 v[52:55], v11, s[32:35], s53 offen offset:3456
    s_cmp_eq_u32 s42, 9
    s_cbranch_scc1 k_fpol
    s_barrier
    s_cmp_lg_u32 s65, 0
    s_cbranch_scc1 k_fperm
    buffer_load_dwordx4 v[132:135], v12, s[36:39], 0 offen offset:0
    buffer_load_dwordx4 v[136:139], v12, s[36:39], 0 offen offset:1280
    buffer_load_dwordx4 v[140:143], v12, s[36:39], 0 offen offset:2560
    buffer_load_dwordx4 v[144:147], v12, s[36:39], 0 offen offset:3840
    buffer_load_dwordx4 v[148:151], v12, s[36:39], s56 offen offset:0
    buffer_load_dwordx4 v[152:155], v12, s[36:39], s56 offen offset:1280
    buffer_load_dwordx4 v[156:159], v12, s[36:39], s56 offen offset:2560
    buffer_load_dwordx4 v[160:163], v12, s[36:39], s56 offen offset:3840
    s_waitcnt vmcnt(8)
    v_perm_b32 v56, v28, v24, s62
    v_perm_b32 v57, v36, v32, s62
    v_perm_b32 v58, v44, v40, s62
    v_perm_b32 v59, v52, v48, s62
    v_perm_b32 v60, v28, v24, s63
    v_perm_b32 v61, v36, v32, s63
    v_perm_b32 v62, v44, v40, s63
    v_perm_b32 v63, v52, v48, s63
    v_perm_b32 v64, v29, v25, s62
    v_perm_b32 v65, v37, v33, s62
    v_perm_b32 v66, v45, v41, s62
    v_perm_b32 v67, v53, v49, s62
    v_perm_b32 v68, v29, v25, s63
    v_perm_b32 v69, v37, v33, s63
    v_perm_b32 v70, v45, v41, s63
    v_perm_b32 v71, v53, v49, s63
    v_perm_b32 v72, v30, v26, s62
    v_perm_b32 v73, v38, v34, s62
    v_perm_b32 v74, v46, v42, s62
    v_perm_b32 v75, v54, v50, s62
    v_perm_b32 v76, v30, v26, s63
    v_perm_b32 v77, v38, v34, s63
    v_perm_b32 v78, v46, v42, s63
    v_perm_b32 v79, v54, v50, s63
    v_perm_b32 v80, v31, v27, s62
    v_perm_b32 v81, v39, v35, s62
    v_perm_b32 v82, v47, v43, s62
    v_perm_b32 v83, v55, v51, s62
    v_perm_b32 v84, v31, v27, s63
    v_perm_b32 v85, v39, v35, s63
    v_perm_b32 v86, v47, v43, s63
    v_perm_b32 v87, v55, v51, s63
    s_waitcnt vmcnt(0)
    v_perm_b32 v88, v136, v132, s62
    v_perm_b32 v89, v144, v140, s62
    v_perm_b32 v90, v152, v148, s62
    v_perm_b32 v91, v160, v156, s62
    v_perm_b32 v92, v136, v132, s63
    v_perm_b32 v93, v144, v140, s63
    v_perm_b32 v94, v152, v148, s63
    v_perm_b32 v95, v160, v156, s63
    v_perm_b32 v96, v137, v133, s62
    v_perm_b32 v97, v145, v141, s62
    v_perm_b32 v98, v153, v149, s62
    v_perm_b32 v99, v161, v157, s62
    v_perm_b32 v100, v137, v133, s63
    v_perm_b32 v101, v145, v141, s63
    v_perm_b32 v102, v153, v149, s63
    v_perm_b32 v103, v161, v157, s63
    v_perm_b32 v104, v138, v134, s62
    v_perm_b32 v105, v146, v142, s62
    v_perm_b32 v106, v154, v150, s62
    v_perm_b32 v107, v162, v158, s62
    v_perm_b32 v108, v138, v134, s63
    v_perm_b32 v109, v146, v142, s63
    v_perm_b32 v110, v154, v150, s63
    v_perm_b32 v111, v162, v158, s63
    v_perm_b32 v112, v139, v135, s62
    v_perm_b32 v113, v147, v143, s62
    v_perm_b32 v114, v155, v151, s62
    v_perm_b32 v115, v163, v159, s62
    v_perm_b32 v116, v139, v135, s63
    v_perm_b32 v117, v147, v143, s63
    v_perm_b32 v118, v155, v151, s63
    v_perm_b32 v119, v163, v159, s63
    s_branch k_fbar
k_fpol:
    s_waitcnt lgkmcnt(0)
    s_add_u32 s46, s46, 1
    s_or_b32 s46, s46, 0x80000000
    v_lshlrev_b32 v10, 4, v0
    s_and_b32 s43, s48, 7
    s_mul_i32 s43, s43, 2176
    s_add_u32 s54, s43, 0x00005100
    s_add_u32 s55, s54, 1024
    s_add_u32 s59, s54, 2048
    s_mov_b32 s47, 0
    v_lshlrev_b32 v5, 24, v0
    v_cmp_eq_u32 vcc, 0, v0
    s_nop 1
    v_cndmask_b32 v112, 0, -1, vcc
k_fpoll:
    buffer_load_dwordx4 v[100:103], v10, s[28:31], s54 offen sc1
    buffer_load_dwordx4 v[104:107], v10, s[28:31], s55 offen sc1
    buffer_load_dwordx4 v[108:111], v5, s[28:31], s59 offen sc1
    s_cmp_lg_u32 s47, 0
    s_cbranch_scc1 k_fnb
    s_barrier
k_fnb:
k_fchk:
    s_waitcnt vmcnt(0)
    v_xor_b32 v101, s46, v101
    v_xor_b32 v103, s46, v103
    v_xor_b32 v105, s46, v105
    v_xor_b32 v107, s46, v107
    v_xor_b32 v109, s46, v109
    v_xor_b32 v111, s46, v111
    v_or3_b32 v3, v101, v103, v105
    v_or_b32 v4, v109, v111
    v_and_or_b32 v4, v4, v112, v107
    v_or_b32 v3, v3, v4
    v_max3_u32 v8, v100, v104, v108
    v_cmp_ne_u32 vcc, 0, v3
    s_cbranch_vccz k_fgot
    s_mov_b64 exec, vcc
    s_add_u32 s47, s47, 1
    s_and_b32 s44, s47, 15
    s_cbranch_scc1 nf6
    v_mov_b32 v4, 0
    global_load_dword v3, v4, s[16:17] sc1
    s_waitcnt vmcnt(0)
    v_readfirstlane_b32 s44, v3
    s_nop 3
    s_cmp_eq_u32 s44, 0
    s_cselect_b32 s46, s46, s44
nf6:
    s_cmp_lt_u32 s47, 131072
    s_cbranch_scc1 k_fpoll
k_fgot:
    s_setprio 3
    s_mov_b64 exec, -1
    v_max_u32_dpp v3, v8, v8 quad_perm:[1,0,3,2] row_mask:0xf bank_mask:0xf
    v_med3_u32 v9, v100, v104, v108
    v_max3_u32 v4, v102, v106, v110
    v_max_u32_dpp v3, v3, v3 quad_perm:[2,3,0,1] row_mask:0xf bank_mask:0xf
    v_max_u32 v9, v9, v4
    v_lshlrev_b32 v10, 4, v0
    v_max_u32_dpp v3, v3, v3 row_half_mirror row_mask:0xf bank_mask:0xf
    v_lshlrev_b32 v112, 2, v0
    s_nop 0
    v_max_u32_dpp v3, v3, v3 row_mirror row_mask:0xf bank_mask:0xf
    s_nop 1
    v_max_u32_dpp v3, v3, v3 row_bcast:15 row_mask:0xa bank_mask:0xf
    s_nop 1
    v_max_u32_dpp v3, v3, v3 row_bcast:31 row_mask:0xc bank_mask:0xf
    s_nop 0
    v_readlane_b32 s22, v3, 63
    s_nop 1
    v_cmp_eq_u32 vcc, s22, v8
    s_and_b32 s43, s22, 2047
    s_mul_i32 s43, s43, 1280
    buffer_load_dwordx4 v[88:91], v10, s[24:27], s43 offen
    buffer_load_dword v96, v112, s[24:27], s43 offen offset:1024
    v_cndmask_b32 v3, v8, v9, vcc
    s_nop 1
    v_max_u32_dpp v3, v3, v3 quad_perm:[1,0,3,2] row_mask:0xf bank_mask:0xf
    s_nop 1
    v_max_u32_dpp v3, v3, v3 quad_perm:[2,3,0,1] row_mask:0xf bank_mask:0xf
    s_nop 1
    v_max_u32_dpp v3, v3, v3 row_half_mirror row_mask:0xf bank_mask:0xf
    s_nop 1
    v_max_u32_dpp v3, v3, v3 row_mirror row_mask:0xf bank_mask:0xf
    s_nop 1
    v_max_u32_dpp v3, v3, v3 row_bcast:15 row_mask:0xa bank_mask:0xf
    s_nop 1
    v_max_u32_dpp v3, v3, v3 row_bcast:31 row_mask:0xc bank_mask:0xf
    s_nop 0
    v_readlane_b32 s23, v3, 63
    s_and_b32 s43, s23, 2047
    s_mul_i32 s43, s43, 1280
    buffer_load_dwordx4 v[92:95], v10, s[24:27], s43 offen
    buffer_load_dword v97, v112, s[24:27], s43 offen offset:1024
    v_mov_b32 v3, s22
    v_mov_b32 v4, s23
    v_cmp_eq_u32 vcc, 0, v2
    s_mov_b32 s60, 0x00001000
    s_mov_b32 s47, 0
    v_cndmask_b32 v3, v4, v3, vcc
    v_and_b32 v3, 2047, v3
    v_sub_u32 v4, 2048, v3
    v_and_b32 v5, 255, v3
    v_cmp_lt_u32 vcc, 128, v5
    s_nop 1
    v_cndmask_b32 v4, v3, v4, vcc
    v_cndmask_b32 v9, 0, 8, vcc
    v_and_b32 v5, 255, v4
    v_lshrrev_b32 v4, 8, v4
    v_mul_u32_u24 v5, 128, v5
    v_add_u32 v9, v5, v9
    v_lshl_add_u32 v9, v4, 4, v9
    buffer_load_dwordx2 v[98:99], v9, s[28:31], s60 offen sc1
    v_perm_b32 v56, v28, v24, s62
    v_perm_b32 v57, v36, v32, s62
    v_perm_b32 v58, v44, v40, s62
    v_perm_b32 v59, v52, v48, s62
    v_perm_b32 v60, v28, v24, s63
    v_perm_b32 v61, v36, v32, s63
    v_perm_b32 v62, v44, v40, s63
    v_perm_b32 v63, v52, v48, s63
    v_perm_b32 v64, v29, v25, s62
    v_perm_b32 v65, v37, v33, s62
    v_perm_b32 v66, v45, v41, s62
    v_perm_b32 v67, v53, v49, s62
    v_perm_b32 v68, v29, v25, s63
    v_perm_b32 v69, v37, v33, s63
    v_perm_b32 v70, v45, v41, s63
    v_perm_b32 v71, v53, v49, s63
    v_perm_b32 v72, v30, v26, s62
    v_perm_b32 v73, v38, v34, s62
    v_perm_b32 v74, v46, v42, s62
    v_perm_b32 v75, v54, v50, s62
    v_perm_b32 v76, v30, v26, s63
    v_perm_b32 v77, v38, v34, s63
    v_perm_b32 v78, v46, v42, s63
    v_perm_b32 v79, v54, v50, s63
    v_perm_b32 v80, v31, v27, s62
    v_perm_b32 v81, v39, v35, s62
    v_perm_b32 v82, v47, v43, s62
    v_perm_b32 v83, v55, v51, s62
    v_perm_b32 v84, v31, v27, s63
    v_perm_b32 v85, v39, v35, s63
    v_perm_b32 v86, v47, v43, s63
    v_perm_b32 v87, v55, v51, s63
    s_waitcnt vmcnt(3)
    ds_write_b128 v10, v[88:91] offset:8192
    ds_write_b32 v112, v96 offset:9216
    s_waitcnt vmcnt(1)
    ds_write_b128 v10, v[92:95] offset:9472
    ds_write_b32 v112, v97 offset:10496
    s_waitcnt lgkmcnt(0)
    s_branch k_fbar
k_fperm:
    s_waitcnt vmcnt(0)
    v_perm_b32 v56, v28, v24, s62
    v_perm_b32 v57, v36, v32, s62
    v_perm_b32 v58, v44, v40, s62
    v_perm_b32 v59, v52, v48, s62
    v_perm_b32 v60, v28, v24, s63
    v_perm_b32 v61, v36, v32, s63
    v_perm_b32 v62, v44, v40, s63
    v_perm_b32 v63, v52, v48, s63
    v_perm_b32 v64, v29, v25, s62
    v_perm_b32 v65, v37, v33, s62
    v_perm_b32 v66, v45, v41, s62
    v_perm_b32 v67, v53, v49, s62
    v_perm_b32 v68, v29, v25, s63
    v_perm_b32 v69, v37, v33, s63
    v_perm_b32 v70, v45, v41, s63
    v_perm_b32 v71, v53, v49, s63
    v_perm_b32 v72, v30, v26, s62
    v_perm_b32 v73, v38, v34, s62
    v_perm_b32 v74, v46, v42, s62
    v_perm_b32 v75, v54, v50, s62
    v_perm_b32 v76, v30, v26, s63
    v_perm_b32 v77, v38, v34, s63
    v_perm_b32 v78, v46, v42, s63
    v_perm_b32 v79, v54, v50, s63
    v_perm_b32 v80, v31, v27, s62
    v_perm_b32 v81, v39, v35, s62
    v_perm_b32 v82, v47, v43, s62
    v_perm_b32 v83, v55, v51, s62
    v_perm_b32 v84, v31, v27, s63
    v_perm_b32 v85, v39, v35, s63
    v_perm_b32 v86, v47, v43, s63
    v_perm_b32 v87, v55, v51, s63
k_fbar:
    s_mov_b32 exec_lo, 0x00ff00ff
    s_mov_b32 exec_hi, 0x00ff00ff
    s_barrier
    ds_read_b128 v[120:123], v13 offset:8192
    s_mov_b64 exec, -1
    s_waitcnt lgkmcnt(0)
    v_mfma_f32_16x16x32_bf16 v[24:27], v[120:123], v[56:59], 0
    v_mfma_f32_16x16x32_bf16 v[28:31], v[120:123], v[60:63], 0
    v_mfma_f32_16x16x32_bf16 v[32:35], v[120:123], v[64:67], 0
    v_mfma_f32_16x16x32_bf16 v[36:39], v[120:123], v[68:71], 0
    v_mfma_f32_16x16x32_bf16 v[40:43], v[120:123], v[72:75], 0
    v_mfma_f32_16x16x32_bf16 v[44:47], v[120:123], v[76:79], 0
    v_mfma_f32_16x16x32_bf16 v[48:51], v[120:123], v[80:83], 0
    v_mfma_f32_16x16x32_bf16 v[52:55], v[120:123], v[84:87], 0
    s_nop 0
    v_add_f32_dpp v126, v25, v24 row_ror:12 row_mask:0xf bank_mask:0x1
    v_mov_b32_dpp v127, v26 row_ror:8 row_mask:0xf bank_mask:0x1
    v_mov_b32_dpp v128, v27 row_ror:4 row_mask:0xf bank_mask:0x1
    v_add_f32_dpp v126, v30, v29 row_ror:12 row_mask:0xf bank_mask:0x2
    v_mov_b32_dpp v127, v31 row_ror:8 row_mask:0xf bank_mask:0x2
    v_mov_b32_dpp v128, v28 row_ror:4 row_mask:0xf bank_mask:0x2
    v_add_f32_dpp v126, v35, v34 row_ror:12 row_mask:0xf bank_mask:0x4
    v_mov_b32_dpp v127, v32 row_ror:8 row_mask:0xf bank_mask:0x4
    v_mov_b32_dpp v128, v33 row_ror:4 row_mask:0xf bank_mask:0x4
    v_add_f32_dpp v126, v36, v39 row_ror:12 row_mask:0xf bank_mask:0x8
    v_mov_b32_dpp v127, v37 row_ror:8 row_mask:0xf bank_mask:0x8
    v_mov_b32_dpp v128, v38 row_ror:4 row_mask:0xf bank_mask:0x8
    v_add_f32 v126, v126, v127
    v_add_f32 v126, v126, v128
    ds_write_b32 v14, v126 offset:0
    v_add_f32_dpp v129, v41, v40 row_ror:12 row_mask:0xf bank_mask:0x1
    v_mov_b32_dpp v130, v42 row_ror:8 row_mask:0xf bank_mask:0x1
    v_mov_b32_dpp v131, v43 row_ror:4 row_mask:0xf bank_mask:0x1
    v_add_f32_dpp v129, v46, v45 row_ror:12 row_mask:0xf bank_mask:0x2
    v_mov_b32_dpp v130, v47 row_ror:8 row_mask:0xf bank_mask:0x2
    v_mov_b32_dpp v131, v44 row_ror:4 row_mask:0xf bank_mask:0x2
    v_add_f32_dpp v129, v51, v50 row_ror:12 row_mask:0xf bank_mask:0x4
    v_mov_b32_dpp v130, v48 row_ror:8 row_mask:0xf bank_mask:0x4
    v_mov_b32_dpp v131, v49 row_ror:4 row_mask:0xf bank_mask:0x4
    v_add_f32_dpp v129, v52, v55 row_ror:12 row_mask:0xf bank_mask:0x8
    v_mov_b32_dpp v130, v53 row_ror:8 row_mask:0xf bank_mask:0x8
    v_mov_b32_dpp v131, v54 row_ror:4 row_mask:0xf bank_mask:0x8
    v_add_f32 v129, v129, v130
    v_add_f32 v129, v129, v131
    ds_write_b32 v14, v129 offset:3072
    s_cmp_lg_u32 s65, 0
    s_cbranch_scc1 k_fdone
    s_waitcnt lgkmcnt(0)
    s_barrier
    ds_read_b64 v[124:125], v18 offset:10752
    ds_read_b128 v[144:147], v17 offset:1536
    ds_read_b128 v[148:151], v17 offset:1552
    ds_read_b64 v[142:143], v17 offset:1568
    ds_read_b128 v[132:135], v15 offset:0
    ds_read_b128 v[136:139], v15 offset:16
    ds_read_b64 v[140:141], v15 offset:32
    s_waitcnt lgkmcnt(3)
    v_lshlrev_b32 v8, 16, v124
    v_and_b32 v9, s45, v124
    v_rcp_f32 v8, v8
    v_add_f32 v144, v144, v145
    v_add_f32 v149, v149, v150
    v_add_f32 v146, v146, v147
    v_add_f32 v151, v151, v142
    v_add_f32 v144, v144, v148
    v_add_f32 v149, v149, v143
    v_add_f32 v144, v144, v146
    v_add_f32 v149, v149, v151
    s_waitcnt lgkmcnt(0)
    v_fma_f32 v136, -v9, v144, v136
    v_fma_f32 v141, -v9, v149, v141
    v_add_f32 v3, v132, v133
    v_add_f32 v4, v137, v138
    v_add_f32 v5, v134, v135
    v_add_f32 v139, v139, v140
    v_add_f32 v3, v3, v136
    v_add_f32 v4, v4, v141
    v_add_f32 v3, v3, v5
    v_add_f32 v4, v4, v139
    v_mul_f32 v3, v3, v8
    v_mul_f32 v4, v4, v8
    v_mul_f32 v5, 0xbfb8aa3b, v3
    v_exp_f32 v5, v5
    v_mul_f32 v3, v3, v4
    v_add_f32 v5, 1.0, v5
    v_rcp_f32 v5, v5
    v_mov_b32 v141, v125
    v_mul_f32 v3, v3, v5
    v_cvt_pk_bf16_f32 v3, v3, v3
    v_and_b32 v3, v3, v20
    v_mov_b32 v143, v125
    v_cmp_eq_u32 vcc, 0, v21
    v_or_b32_dpp v3, v3, v3 quad_perm:[1,0,3,2] row_mask:0xf bank_mask:0xf
    s_nop 1
    v_mov_b32_dpp v120, v3 quad_perm:[0,0,0,0] row_mask:0xf bank_mask:0xf
    v_mov_b32_dpp v121, v3 quad_perm:[2,2,2,2] row_mask:0xf bank_mask:0xf
    v_mov_b32_dpp v122, v3 quad_perm:[0,0,0,0] row_mask:0xf bank_mask:0xf
    v_mov_b32_dpp v123, v3 quad_perm:[2,2,2,2] row_mask:0xf bank_mask:0xf
    v_mov_b32_dpp v120, v120 row_half_mirror row_mask:0xf bank_mask:0xa
    v_mov_b32_dpp v121, v121 row_half_mirror row_mask:0xf bank_mask:0xa
    v_mov_b32_dpp v122, v122 row_half_mirror row_mask:0xf bank_mask:0x5
    v_mov_b32_dpp v123, v123 row_half_mirror row_mask:0xf bank_mask:0x5
    s_nop 1
    v_mfma_f32_16x16x32_bf16 v[24:27], v[120:123], v[88:91], 0
    v_mfma_f32_16x16x32_bf16 v[28:31], v[120:123], v[92:95], 0
    v_mfma_f32_16x16x32_bf16 v[32:35], v[120:123], v[96:99], 0
    v_mfma_f32_16x16x32_bf16 v[36:39], v[120:123], v[100:103], 0
    v_mfma_f32_16x16x32_bf16 v[40:43], v[120:123], v[104:107], 0
    v_mfma_f32_16x16x32_bf16 v[44:47], v[120:123], v[108:111], 0
    v_mfma_f32_16x16x32_bf16 v[48:51], v[120:123], v[112:115], 0
    v_mfma_f32_16x16x32_bf16 v[52:55], v[120:123], v[116:119], 0
    s_nop 1
    v_cvt_pk_bf16_f32 v132, v24, v28
    s_nop 0
    v_cvt_pk_bf16_f32 v133, v32, v36
    s_nop 0
    v_cvt_pk_bf16_f32 v134, v40, v44
    s_nop 0
    v_cvt_pk_bf16_f32 v135, v48, v52
    v_cndmask_b32 v140, v134, v132, vcc
    v_cndmask_b32 v142, v135, v133, vcc
    buffer_store_dwordx4 v[140:143], v16, s[28:31], s57 offen sc1
    s_endpgm
k_fdone:
    s_cmp_lg_u32 s42, 9
    s_cbranch_scc1 k_fdon2
    v_lshlrev_b32 v5, 3, v2
k_fsp:
    s_waitcnt vmcnt(0)
    v_cmp_ne_u32 vcc, s46, v99
    s_cbranch_vccz k_fsq
    buffer_load_dwordx2 v[98:99], v9, s[28:31], s60 offen sc1
    s_add_u32 s47, s47, 1
    s_cmp_lt_u32 s47, 131072
    s_cbranch_scc1 k_fsp
    s_waitcnt vmcnt(0)
k_fsq:
    ds_write_b64 v5, v[98:99] offset:10752
    s_cmp_lg_u32 s2, 129
    s_cbranch_scc1 k_fdon2
    s_waitcnt lgkmcnt(0)
    s_barrier
    v_mov_b32 v5, 0
    v_mov_b32 v3, s46
    s_mov_b64 exec, 1
    global_store_dword v5, v3, s[16:17] sc1
    s_waitcnt vmcnt(0)
    buffer_store_dword v3, v5, s[28:31], 0 offen offset:0 sc1
    s_endpgm
k_fdon2:
    s_waitcnt lgkmcnt(0)
k_end:
k_last:
    s_endpgm
.section .rodata,"a"
.p2align 6
.amdhsa_kernel recurrent_scan__spectral_fnet__moe_arch_mod__prompt_kernel
  .amdhsa_next_free_vgpr 168
  .amdhsa_next_free_sgpr 71
  .amdhsa_accum_offset 168
  .amdhsa_group_segment_fixed_size 0
  .amdhsa_kernarg_size 104
  .amdhsa_user_sgpr_count 2
  .amdhsa_user_sgpr_kernarg_segment_ptr 1
  .amdhsa_system_sgpr_workgroup_id_x 1
  .amdhsa_float_denorm_mode_32 3
  .amdhsa_float_denorm_mode_16_64 3
.end_amdhsa_kernel
```
